```python
import torch

def _softmax(x, axis=-1):
    return torch.softmax(x, dim=axis)
def _gelu(x):
    return torch.nn.functional.gelu(x, approximate="tanh")
def _silu(x):
    return torch.nn.functional.silu(x)
def _sigmoid(x):
    return torch.sigmoid(x)
def _layernorm(x, axis=-1, eps=1e-5):
    m = x.mean(dim=axis, keepdim=True)
    v = x.var(dim=axis, keepdim=True, unbiased=False)
    return (x - m) / torch.sqrt(v + eps)
def _scatter_add(tgt, idx, src, axis=0):
    return tgt.clone().index_add_(axis, idx, src)
def _segment_sum(src, seg, n):
    out = torch.zeros((n,) + src.shape[1:], dtype=src.dtype)
    return out.index_add_(0, seg, src)
def _pad(x, pw):
    flat = tuple(v for pair in reversed(pw) for v in pair)
    return torch.nn.functional.pad(x, flat)

kernel_name = 'standalone__gqa_block_cached__near_ridge'

def setup_inputs():

    _w = (lambda a: (lambda t: t.to(torch.bfloat16) if t.is_floating_point() else t)(torch.as_tensor(a)))
    B, Sq, D = 16, 32, 1024
    Hq, Hkv, Sk, Dh = 32, 4, 512, 128
    assert Hq % Hkv == 0, (Hq, Hkv)
    return {
        "x": _w((lambda *s: torch.randn(*s, dtype=torch.bfloat16) * 0.8)(B, Sq, D)),
        "k_cache": _w((lambda *s: torch.randn(*s, dtype=torch.bfloat16) * 0.8)(B, Hkv, Sk, Dh)),
        "v_cache": _w((lambda *s: torch.randn(*s, dtype=torch.bfloat16) * 0.05)(B, Hkv, Sk, Dh)),
        "wq": _w((lambda *s: torch.randn(*s, dtype=torch.bfloat16) * 0.8)(D, Hq * Dh) * (D ** -0.5)),
        "wo": _w((lambda *s: torch.randn(*s, dtype=torch.bfloat16) * 0.05)(Hq * Dh, D) * ((Hq * Dh) ** -0.5)),
    }

def reference(x, k_cache, v_cache, wq, wo):
    B, Sq, D = x.shape
    Hq, Dh = 32, 128
    Hkv = k_cache.shape[1]
    rep = Hq // Hkv
    q = (lambda x, *d: x.permute(*d))((x @ wq).reshape(B, Sq, Hq, Dh), 0, 2, 1, 3)
    k = (lambda x, n, axis: torch.repeat_interleave(x, n, dim=axis))(k_cache, rep, axis=1)
    v = (lambda x, n, axis: torch.repeat_interleave(x, n, dim=axis))(v_cache, rep, axis=1)
    scores = torch.einsum("bhqd,bhkd->bhqk", q, k) * (Dh ** -0.5)
    p = _softmax(scores, axis=-1)
    o = torch.einsum("bhqk,bhkd->bhqd", p, v)
    return (lambda x, *d: x.permute(*d))(o, 0, 2, 1, 3).reshape(B, Sq, Hq * Dh) @ wo
```

```asm
; @launch grid=(256,1,1) block=(256,1,1) lds=163840
.amdgcn_target "amdgcn-amd-amdhsa--gfx950"
.text
.globl standalone__gqa_block_cached__near_ridge_kernel
.p2align 8
.type standalone__gqa_block_cached__near_ridge_kernel,@function
standalone__gqa_block_cached__near_ridge_kernel:
    s_cmp_ge_u32 s2, 256
    s_cbranch_scc1 L_exit
    s_load_dwordx16 s[64:79], s[0:1], 0
    s_getpc_b64 s[62:63]
L_pc:
    s_lshr_b32 s56, s2, 3
    s_lshl_b32 s56, s56, 10
    v_and_b32 v2, 7, v0
    v_lshl_add_u32 v2, v2, 7, s56
    v_min_u32 v2, L_exit-L_pc, v2
    v_and_b32 v2, 0xfffffffc, v2
    s_mov_b64 exec, 0xff
    global_load_dword v10, v2, s[62:63]
    s_mov_b64 exec, -1
    v_and_b32 v9, 63, v0
    v_lshrrev_b32 v1, 6, v0
    s_nop 0
    v_readfirstlane_b32 s39, v1
    s_and_b32 s36, s2, 3
    s_lshr_b32 s37, s2, 3
    s_and_b32 s37, s37, 7
    s_lshr_b32 s51, s2, 6
    s_bfe_u32 s53, s2, 0x10002
    s_lshl_b32 s38, s53, 2
    s_add_u32 s38, s38, s51
    s_lshr_b32 s40, s37, 1
    s_and_b32 s41, s37, 1
    s_lshr_b32 s42, s39, 1
    s_and_b32 s43, s39, 1
    s_lshl_b32 s44, s39, 11
    s_mul_i32 s55, s51, 4
    s_mul_i32 s56, s37, 2
    s_add_u32 s55, s55, s56
    s_and_b32 s55, s55, 15
    s_lshl_b32 s57, s40, 1
    s_lshl_b32 s45, s55, 7
    s_sub_u32 s45, s45, 128
    s_and_b32 s45, s45, 2047
    s_lshl_b32 s46, s55, 19
    s_sub_u32 s46, s46, 262144
    s_and_b32 s46, s46, 0x7fffff
    s_lshl_b32 s47, s57, 13
    s_sub_u32 s47, s47, 8192
    s_and_b32 s47, s47, 0xffff
    s_mov_b32 s48, s47
    s_lshl_b32 s56, s40, 2
    s_lshl_b32 s94, s56, 17
    s_lshl_b32 s50, s56, 13
    s_sub_u32 s50, s50, 8192
    s_and_b32 s50, s50, 0x1ffff
    s_lshl_b32 s56, s51, 1
    s_add_u32 s56, s56, s37
    s_and_b32 s53, s56, 7
    v_lshlrev_b32 v23, 4, v9
    v_add_u32 v22, s44, v23
    v_lshrrev_b32 v1, 4, v9
    v_bfe_u32 v2, v9, 2, 2
    v_xor_b32 v2, v2, v1
    v_lshlrev_b32 v2, 6, v2
    v_and_b32 v3, 3, v9
    v_lshl_add_u32 v2, v3, 4, v2
    s_lshl_b32 s56, s39, 3
    v_add_u32 v3, s56, v1
    v_lshl_add_u32 v13, v3, 13, v2
    v_add_u32 v14, 31744, v13
    v_lshl_add_u32 v15, v3, 11, v2
    v_add_u32 v16, 7168, v15
    v_lshl_add_u32 v19, v3, 8, v2
    v_and_b32 v4, 15, v9
    s_lshl_b32 s56, s43, 3
    v_add_u32 v5, s56, v1
    v_xor_b32 v5, v5, v4
    v_lshlrev_b32 v6, 8, v3
    v_lshl_add_u32 v17, v5, 4, v6
    v_xor_b32 v18, 64, v17
    v_lshrrev_b32 v1, 3, v9
    v_and_b32 v2, 7, v9
    v_lshrrev_b32 v3, 1, v1
    v_xor_b32 v2, v2, v3
    s_lshl_b32 s56, s39, 4
    v_add_u32 v4, s56, v1
    s_lshl_b32 s56, s41, 5
    v_xor_b32 v4, s56, v4
    v_lshlrev_b32 v4, 11, v4
    v_lshl_add_u32 v11, v2, 4, v4
    v_xor_b32 v12, 64, v11
    v_add_u32 v12, 15360, v12
    s_waitcnt lgkmcnt(0)
    s_lshl_b32 s56, s38, 17
    s_add_u32 s8, s64, s56
    s_addc_u32 s9, s65, 0
    s_mov_b32 s11, 0x00020000
    s_mov_b32 s10, 131072
    s_lshl_b32 s58, s36, 3
    s_add_u32 s58, s58, s37
    s_lshl_b32 s56, s58, 8
    s_add_u32 s20, s70, s56
    s_addc_u32 s21, s71, 0
    s_mov_b32 s23, 0x00020000
    s_sub_u32 s22, 0x800000, s56
    s_add_u32 m0, s44, 147456
    s_add_u32 s45, s45, 128
    s_and_b32 s45, s45, 2047
    buffer_load_dwordx4 v11, s[8:11], s45 offen  lds
    buffer_load_dwordx4 v12, s[8:11], s45 offen offset:1024  lds
    s_add_u32 m0, s44, 0
    s_add_u32 s46, s46, 262144
    s_and_b32 s46, s46, 0x7fffff
    buffer_load_dwordx4 v13, s[20:23], s46 offen  lds
    buffer_load_dwordx4 v14, s[20:23], s46 offen offset:1024  lds
    s_add_u32 m0, s44, 8192
    s_add_u32 s46, s46, 262144
    s_and_b32 s46, s46, 0x7fffff
    buffer_load_dwordx4 v13, s[20:23], s46 offen  lds
    buffer_load_dwordx4 v14, s[20:23], s46 offen offset:1024  lds
    s_add_u32 m0, s44, 155648
    s_add_u32 s45, s45, 128
    s_and_b32 s45, s45, 2047
    buffer_load_dwordx4 v11, s[8:11], s45 offen  lds
    buffer_load_dwordx4 v12, s[8:11], s45 offen offset:1024  lds
    s_lshl_b32 s59, s38, 1
    s_add_u32 s59, s59, s41
    s_lshl_b32 s59, s59, 2
    s_add_u32 s59, s59, s36
    s_lshl_b32 s56, s59, 17
    s_add_u32 s12, s66, s56
    s_addc_u32 s13, s67, 0
    s_mov_b32 s15, 0x00020000
    s_mov_b32 s14, 131072
    s_add_u32 s16, s68, s56
    s_addc_u32 s17, s69, 0
    s_mov_b32 s19, 0x00020000
    s_mov_b32 s18, 131072
    s_lshl_b32 s56, s36, 21
    s_lshl_b32 s58, s53, 8
    s_add_u32 s56, s56, s58
    s_add_u32 s24, s72, s56
    s_addc_u32 s25, s73, 0
    s_mov_b32 s27, 0x00020000
    s_sub_u32 s26, 0x800000, s56
    s_mov_b32 s56, 0
    s_add_u32 s28, s74, s56
    s_addc_u32 s29, s75, 0
    s_mov_b32 s31, 0x00020000
    s_mov_b32 s30, 1048576
    s_add_u32 s32, s78, s56
    s_addc_u32 s33, s79, 0
    s_mov_b32 s35, 0x00020000
    s_mov_b32 s34, 16777216
    s_and_b32 s60, s2, 7
    s_lshr_b32 s58, s2, 6
    s_lshl_b32 s58, s58, 3
    s_add_u32 s60, s60, s58
    s_lshl_b32 s56, s60, 17
    s_add_u32 s56, s56, 4193280
    s_add_u32 s80, s78, s56
    s_addc_u32 s81, s79, 0
    s_mov_b32 s83, 0x00020000
    s_mov_b32 s82, 132096
    s_lshl_b32 s56, s38, 8
    v_mov_b32 v1, s56
    buffer_load_dword v24, v1, s[32:35], 0 offen sc1
    v_mov_b32 v4, 0
    s_mov_b32 s56, 0x300000
    s_lshl_b32 s58, s2, 15
    s_add_u32 s58, s58, 8413184
    s_mov_b64 exec, 1
    buffer_load_dword v200, v4, s[12:15], 0 offen offset:1024
    buffer_load_dword v201, v4, s[16:19], 0 offen offset:1024
    buffer_load_dword v202, v4, s[24:27], 0 offen offset:1024
    buffer_load_dword v205, v4, s[32:35], s56 offen
    buffer_load_dword v206, v4, s[32:35], s58 offen
    s_mov_b64 exec, -1
    s_lshr_b32 s56, s36, 1
    s_lshl_b32 s56, s56, 10
    v_add_u32 v4, 1024, v22
    v_add_u32 v20, s56, v4
    v_subrev_u32 v21, s56, v4
    v_bfe_u32 v25, v9, 2, 2
    v_and_b32 v5, 1, v9
    v_lshlrev_b32 v5, 4, v5
    v_bfe_u32 v6, v9, 1, 1
    v_lshl_add_u32 v26, v6, 3, v5
    v_bfe_u32 v27, v9, 4, 1
    v_lshrrev_b32 v28, 5, v9
    v_xor_b32 v5, s39, v25
    v_lshlrev_b32 v5, 6, v5
    v_lshl_add_u32 v5, v25, 8, v5
    v_lshl_add_u32 v5, v28, 11, v5
    v_lshl_add_u32 v5, v27, 5, v5
    v_add_u32 v7, v5, v26
    v_mov_b32 v29, v7
    v_add_u32 v30, 0x10000, v7
    v_add_u32 v31, 0x20000, v7
    v_and_b32 v5, 31, v9
    v_bfe_u32 v6, v9, 1, 3
    v_xor_b32 v6, v6, v28
    v_lshlrev_b32 v6, 4, v6
    v_lshl_add_u32 v7, v5, 7, v6
    v_xor_b32 v8, 0, v7
    v_mov_b32 v32, v8
    v_add_u32 v33, 0x10000, v8
    v_add_u32 v34, 0x20000, v8
    v_xor_b32 v8, 32, v7
    v_mov_b32 v35, v8
    v_add_u32 v36, 0x10000, v8
    v_add_u32 v37, 0x20000, v8
    v_xor_b32 v8, 64, v7
    v_mov_b32 v38, v8
    v_add_u32 v39, 0x10000, v8
    v_add_u32 v40, 0x20000, v8
    v_xor_b32 v8, 96, v7
    v_mov_b32 v41, v8
    v_add_u32 v42, 0x10000, v8
    v_add_u32 v43, 0x20000, v8
    s_add_u32 m0, s44, 16384
    s_add_u32 s46, s46, 262144
    s_and_b32 s46, s46, 0x7fffff
    buffer_load_dwordx4 v13, s[20:23], s46 offen  lds
    buffer_load_dwordx4 v14, s[20:23], s46 offen offset:1024  lds
    s_add_u32 m0, s44, 24576
    s_add_u32 s46, s46, 262144
    s_and_b32 s46, s46, 0x7fffff
    buffer_load_dwordx4 v13, s[20:23], s46 offen  lds
    buffer_load_dwordx4 v14, s[20:23], s46 offen offset:1024  lds
    s_add_u32 m0, s44, 32768
    s_add_u32 s45, s45, 128
    s_and_b32 s45, s45, 2047
    buffer_load_dwordx4 v11, s[8:11], s45 offen  lds
    buffer_load_dwordx4 v12, s[8:11], s45 offen offset:1024  lds
    s_add_u32 m0, s44, 49152
    s_add_u32 s46, s46, 262144
    s_and_b32 s46, s46, 0x7fffff
    buffer_load_dwordx4 v13, s[20:23], s46 offen  lds
    buffer_load_dwordx4 v14, s[20:23], s46 offen offset:1024  lds
    s_waitcnt vmcnt(16)
    s_barrier
    ds_read_b64_tr_b16 a[0:1], v29 offset:0
    ds_read_b64_tr_b16 a[2:3], v29 offset:1024
    ds_read_b128 a[12:15], v34 offset:16384
    ds_read_b128 a[16:19], v34 offset:20480
    ds_read_b64_tr_b16 a[4:5], v29 offset:4096
    ds_read_b64_tr_b16 a[6:7], v29 offset:5120
    ds_read_b128 a[20:23], v37 offset:16384
    ds_read_b128 a[24:27], v37 offset:20480
    s_waitcnt lgkmcnt(4)
    v_mfma_f32_32x32x16_bf16 v[88:103], a[0:3], a[12:15], 0
    s_add_u32 m0, s44, 57344
    s_add_u32 s46, s46, 262144
    s_and_b32 s46, s46, 0x7fffff
    buffer_load_dwordx4 v13, s[20:23], s46 offen  lds
    ds_read_b64_tr_b16 a[8:9], v29 offset:8192
    ds_read_b64_tr_b16 a[10:11], v29 offset:9216
    v_mfma_f32_32x32x16_bf16 v[104:119], a[0:3], a[16:19], 0
    buffer_load_dwordx4 v14, s[20:23], s46 offen offset:1024  lds
    ds_read_b128 a[28:31], v40 offset:16384
    ds_read_b128 a[32:35], v40 offset:20480
    s_waitcnt lgkmcnt(4)
    v_mfma_f32_32x32x16_bf16 v[88:103], a[4:7], a[20:23], v[88:103]
    s_add_u32 m0, s44, 40960
    s_add_u32 s45, s45, 128
    s_and_b32 s45, s45, 2047
    buffer_load_dwordx4 v11, s[8:11], s45 offen  lds
    ds_read_b64_tr_b16 a[0:1], v29 offset:12288
    ds_read_b64_tr_b16 a[2:3], v29 offset:13312
    v_mfma_f32_32x32x16_bf16 v[104:119], a[4:7], a[24:27], v[104:119]
    buffer_load_dwordx4 v12, s[8:11], s45 offen offset:1024  lds
    ds_read_b128 a[12:15], v43 offset:16384
    ds_read_b128 a[16:19], v43 offset:20480
    s_waitcnt vmcnt(8)
    s_barrier
    s_waitcnt lgkmcnt(4)
    v_mfma_f32_32x32x16_bf16 v[88:103], a[8:11], a[28:31], v[88:103]
    s_add_u32 m0, s44, 65536
    s_add_u32 s46, s46, 262144
    s_and_b32 s46, s46, 0x7fffff
    buffer_load_dwordx4 v13, s[20:23], s46 offen  lds
    ds_read_b64_tr_b16 a[4:5], v29 offset:16384
    ds_read_b64_tr_b16 a[6:7], v29 offset:17408
    v_readfirstlane_b32 s52, v24
    s_nop 3
    s_mul_i32 s52, s52, 0x9E3779B1
    v_mfma_f32_32x32x16_bf16 v[104:119], a[8:11], a[32:35], v[104:119]
    buffer_load_dwordx4 v14, s[20:23], s46 offen offset:1024  lds
    ds_read_b128 a[20:23], v34 offset:24576
    ds_read_b128 a[24:27], v34 offset:28672
    s_add_u32 s52, s52, 0x7F4A7C15
    v_mov_b32 v44, s52
    s_waitcnt lgkmcnt(4)
    v_mfma_f32_32x32x16_bf16 v[88:103], a[0:3], a[12:15], v[88:103]
    s_add_u32 m0, s44, 73728
    s_add_u32 s46, s46, 262144
    s_and_b32 s46, s46, 0x7fffff
    buffer_load_dwordx4 v13, s[20:23], s46 offen  lds
    ds_read_b64_tr_b16 a[8:9], v29 offset:20480
    ds_read_b64_tr_b16 a[10:11], v29 offset:21504
    v_add_u32 v48, 0x20000, v22
    s_getreg_b32 s93, hwreg(HW_REG_XCC_ID, 0, 4)
    v_mfma_f32_32x32x16_bf16 v[104:119], a[0:3], a[16:19], v[104:119]
    buffer_load_dwordx4 v14, s[20:23], s46 offen offset:1024  lds
    ds_read_b128 a[28:31], v37 offset:24576
    ds_read_b128 a[32:35], v37 offset:28672
    s_add_u32 s93, s93, s52
    v_mov_b32 v87, s93
    s_waitcnt lgkmcnt(4)
    v_mfma_f32_32x32x16_bf16 v[88:103], a[4:7], a[20:23], v[88:103]
    s_add_u32 m0, s44, 81920
    s_add_u32 s45, s45, 128
    s_and_b32 s45, s45, 2047
    buffer_load_dwordx4 v11, s[8:11], s45 offen  lds
    ds_read_b64_tr_b16 a[0:1], v29 offset:24576
    ds_read_b64_tr_b16 a[2:3], v29 offset:25600
    s_lshl_b32 s56, s2, 7
    s_add_u32 s56, s56, 229376
    v_mfma_f32_32x32x16_bf16 v[104:119], a[4:7], a[24:27], v[104:119]
    buffer_load_dwordx4 v12, s[8:11], s45 offen offset:1024  lds
    ds_read_b128 a[12:15], v40 offset:24576
    ds_read_b128 a[16:19], v40 offset:28672
    v_mov_b32 v86, s56
    s_mov_b64 exec, 1
    buffer_store_dword v87, v86, s[32:35], 0 offen sc1
    s_mov_b64 exec, -1
    s_waitcnt lgkmcnt(4)
    v_mfma_f32_32x32x16_bf16 v[88:103], a[8:11], a[28:31], v[88:103]
    s_add_u32 m0, s44, 98304
    s_add_u32 s46, s46, 262144
    s_and_b32 s46, s46, 0x7fffff
    buffer_load_dwordx4 v13, s[20:23], s46 offen  lds
    ds_read_b64_tr_b16 a[4:5], v29 offset:28672
    ds_read_b64_tr_b16 a[6:7], v29 offset:29696
    s_and_b32 s58, s2, 0xc7
    s_lshl_b32 s58, s58, 7
    v_mfma_f32_32x32x16_bf16 v[104:119], a[8:11], a[32:35], v[104:119]
    buffer_load_dwordx4 v14, s[20:23], s46 offen offset:1024  lds
    ds_read_b128 a[20:23], v43 offset:24576
    ds_read_b128 a[24:27], v43 offset:28672
    s_add_u32 s58, s58, 229376
    v_and_b32 v248, 7, v9
    s_waitcnt vmcnt(11)
    s_barrier
    s_waitcnt lgkmcnt(4)
    v_mfma_f32_32x32x16_bf16 v[88:103], a[0:3], a[12:15], v[88:103]
    s_add_u32 m0, s44, 106496
    s_add_u32 s46, s46, 262144
    s_and_b32 s46, s46, 0x7fffff
    buffer_load_dwordx4 v13, s[20:23], s46 offen  lds
    ds_read_b64_tr_b16 a[8:9], v29 offset:49152
    ds_read_b64_tr_b16 a[10:11], v29 offset:50176
    v_lshl_add_u32 v248, v248, 10, s58
    s_lshl_b32 s56, s2, 7
    v_mfma_f32_32x32x16_bf16 v[104:119], a[0:3], a[16:19], v[104:119]
    buffer_load_dwordx4 v14, s[20:23], s46 offen offset:1024  lds
    ds_read_b128 a[28:31], v32 offset:32768
    ds_read_b128 a[32:35], v32 offset:36864
    s_add_u32 s56, s56, 65536
    v_mov_b32 v46, s56
    s_waitcnt lgkmcnt(4)
    v_mfma_f32_32x32x16_bf16 v[88:103], a[4:7], a[20:23], v[88:103]
    s_add_u32 m0, s44, 90112
    s_add_u32 s45, s45, 128
    s_and_b32 s45, s45, 2047
    buffer_load_dwordx4 v11, s[8:11], s45 offen  lds
    ds_read_b64_tr_b16 a[0:1], v29 offset:53248
    ds_read_b64_tr_b16 a[2:3], v29 offset:54272
    s_xor_b32 s56, s2, 8
    s_lshl_b32 s56, s56, 7
    v_mfma_f32_32x32x16_bf16 v[104:119], a[4:7], a[24:27], v[104:119]
    buffer_load_dwordx4 v12, s[8:11], s45 offen offset:1024  lds
    ds_read_b128 a[12:15], v35 offset:32768
    ds_read_b128 a[16:19], v35 offset:36864
    s_add_u32 s56, s56, 65536
    v_mov_b32 v47, s56
    s_waitcnt lgkmcnt(4)
    v_mfma_f32_32x32x16_bf16 v[88:103], a[8:11], a[28:31], v[88:103]
    s_add_u32 m0, s44, 114688
    s_add_u32 s46, s46, 262144
    s_and_b32 s46, s46, 0x7fffff
    buffer_load_dwordx4 v13, s[20:23], s46 offen  lds
    ds_read_b64_tr_b16 a[4:5], v29 offset:57344
    ds_read_b64_tr_b16 a[6:7], v29 offset:58368
    v_and_b32 v5, 31, v9
    v_and_b32 v6, 15, v9
    v_mfma_f32_32x32x16_bf16 v[104:119], a[8:11], a[32:35], v[104:119]
    buffer_load_dwordx4 v14, s[20:23], s46 offen offset:1024  lds
    ds_read_b128 a[20:23], v38 offset:32768
    ds_read_b128 a[24:27], v38 offset:36864
    v_xor_b32 v6, v6, v28
    v_lshlrev_b32 v6, 4, v6
    s_waitcnt lgkmcnt(4)
    v_mfma_f32_32x32x16_bf16 v[88:103], a[0:3], a[12:15], v[88:103]
    s_add_u32 m0, s44, 122880
    s_add_u32 s46, s46, 262144
    s_and_b32 s46, s46, 0x7fffff
    buffer_load_dwordx4 v13, s[20:23], s46 offen  lds
    ds_read_b64_tr_b16 a[8:9], v29 offset:61440
    ds_read_b64_tr_b16 a[10:11], v29 offset:62464
    v_lshl_add_u32 v7, v5, 8, v6
    s_lshl_b32 s56, s43, 13
    v_mfma_f32_32x32x16_bf16 v[104:119], a[0:3], a[16:19], v[104:119]
    buffer_load_dwordx4 v14, s[20:23], s46 offen offset:1024  lds
    ds_read_b128 a[28:31], v41 offset:32768
    ds_read_b128 a[32:35], v41 offset:36864
    v_add_u32 v7, s56, v7
    v_xor_b32 v50, 0, v7
    s_waitcnt vmcnt(13)
    s_barrier
    s_waitcnt lgkmcnt(4)
    v_mfma_f32_32x32x16_bf16 v[88:103], a[4:7], a[20:23], v[88:103]
    s_add_u32 m0, s44, 147456
    s_add_u32 s45, s45, 128
    s_and_b32 s45, s45, 2047
    buffer_load_dwordx4 v11, s[8:11], s45 offen  lds
    ds_read_b64_tr_b16 a[0:1], v30 offset:0
    ds_read_b64_tr_b16 a[2:3], v30 offset:1024
    v_add_u32 v51, 0x10000, v50
    v_add_u32 v52, 0x20000, v50
    v_mfma_f32_32x32x16_bf16 v[104:119], a[4:7], a[24:27], v[104:119]
    buffer_load_dwordx4 v12, s[8:11], s45 offen offset:1024  lds
    ds_read_b128 a[12:15], v32 offset:40960
    ds_read_b128 a[16:19], v32 offset:45056
    v_xor_b32 v53, 32, v7
    v_add_u32 v54, 0x10000, v53
    s_waitcnt lgkmcnt(4)
    v_mfma_f32_32x32x16_bf16 v[88:103], a[8:11], a[28:31], v[88:103]
    s_add_u32 m0, s44, 131072
    s_add_u32 s46, s46, 262144
    s_and_b32 s46, s46, 0x7fffff
    buffer_load_dwordx4 v13, s[20:23], s46 offen  lds
    ds_read_b64_tr_b16 a[4:5], v30 offset:4096
    ds_read_b64_tr_b16 a[6:7], v30 offset:5120
    v_add_u32 v55, 0x20000, v53
    v_xor_b32 v56, 64, v7
    v_mfma_f32_32x32x16_bf16 v[104:119], a[8:11], a[32:35], v[104:119]
    buffer_load_dwordx4 v14, s[20:23], s46 offen offset:1024  lds
    ds_read_b128 a[20:23], v35 offset:40960
    ds_read_b128 a[24:27], v35 offset:45056
    v_add_u32 v57, 0x10000, v56
    v_add_u32 v58, 0x20000, v56
    s_waitcnt lgkmcnt(4)
    v_mfma_f32_32x32x16_bf16 v[88:103], a[0:3], a[12:15], v[88:103]
    s_add_u32 m0, s44, 139264
    s_add_u32 s46, s46, 262144
    s_and_b32 s46, s46, 0x7fffff
    buffer_load_dwordx4 v13, s[20:23], s46 offen  lds
    ds_read_b64_tr_b16 a[8:9], v30 offset:8192
    ds_read_b64_tr_b16 a[10:11], v30 offset:9216
    v_xor_b32 v59, 96, v7
    v_add_u32 v60, 0x10000, v59
    v_mfma_f32_32x32x16_bf16 v[104:119], a[0:3], a[16:19], v[104:119]
    buffer_load_dwordx4 v14, s[20:23], s46 offen offset:1024  lds
    ds_read_b128 a[28:31], v38 offset:40960
    ds_read_b128 a[32:35], v38 offset:45056
    v_add_u32 v61, 0x20000, v59
    v_xor_b32 v62, 128, v7
    s_waitcnt lgkmcnt(4)
    v_mfma_f32_32x32x16_bf16 v[88:103], a[4:7], a[20:23], v[88:103]
    s_add_u32 m0, s44, 155648
    s_add_u32 s45, s45, 128
    s_and_b32 s45, s45, 2047
    buffer_load_dwordx4 v11, s[8:11], s45 offen  lds
    ds_read_b64_tr_b16 a[0:1], v30 offset:12288
    ds_read_b64_tr_b16 a[2:3], v30 offset:13312
    v_add_u32 v63, 0x10000, v62
    v_add_u32 v64, 0x20000, v62
    v_mfma_f32_32x32x16_bf16 v[104:119], a[4:7], a[24:27], v[104:119]
    buffer_load_dwordx4 v12, s[8:11], s45 offen offset:1024  lds
    ds_read_b128 a[12:15], v41 offset:40960
    ds_read_b128 a[16:19], v41 offset:45056
    v_xor_b32 v65, 160, v7
    v_add_u32 v66, 0x10000, v65
    s_waitcnt vmcnt(14)
    s_barrier
    s_waitcnt lgkmcnt(4)
    v_mfma_f32_32x32x16_bf16 v[88:103], a[8:11], a[28:31], v[88:103]
    s_add_u32 m0, s44, 0
    s_add_u32 s46, s46, 262144
    s_and_b32 s46, s46, 0x7fffff
    buffer_load_dwordx4 v13, s[20:23], s46 offen  lds
    ds_read_b64_tr_b16 a[4:5], v30 offset:32768
    ds_read_b64_tr_b16 a[6:7], v30 offset:33792
    v_add_u32 v67, 0x20000, v65
    v_xor_b32 v68, 192, v7
    v_mfma_f32_32x32x16_bf16 v[104:119], a[8:11], a[32:35], v[104:119]
    buffer_load_dwordx4 v14, s[20:23], s46 offen offset:1024  lds
    ds_read_b128 a[20:23], v33 offset:16384
    ds_read_b128 a[24:27], v33 offset:20480
    v_add_u32 v69, 0x10000, v68
    v_add_u32 v70, 0x20000, v68
    s_waitcnt lgkmcnt(4)
    v_mfma_f32_32x32x16_bf16 v[88:103], a[0:3], a[12:15], v[88:103]
    s_add_u32 m0, s44, 8192
    s_add_u32 s46, s46, 262144
    s_and_b32 s46, s46, 0x7fffff
    buffer_load_dwordx4 v13, s[20:23], s46 offen  lds
    ds_read_b64_tr_b16 a[8:9], v30 offset:36864
    ds_read_b64_tr_b16 a[10:11], v30 offset:37888
    v_xor_b32 v71, 224, v7
    v_add_u32 v72, 0x10000, v71
    v_mfma_f32_32x32x16_bf16 v[104:119], a[0:3], a[16:19], v[104:119]
    buffer_load_dwordx4 v14, s[20:23], s46 offen offset:1024  lds
    ds_read_b128 a[28:31], v36 offset:16384
    ds_read_b128 a[32:35], v36 offset:20480
    v_add_u32 v73, 0x20000, v71
    s_lshl_b32 s56, s43, 1
    s_waitcnt lgkmcnt(4)
    v_mfma_f32_32x32x16_bf16 v[88:103], a[4:7], a[20:23], v[88:103]
    s_add_u32 m0, s44, 16384
    s_add_u32 s45, s45, 128
    s_and_b32 s45, s45, 2047
    buffer_load_dwordx4 v11, s[8:11], s45 offen  lds
    ds_read_b64_tr_b16 a[0:1], v30 offset:40960
    ds_read_b64_tr_b16 a[2:3], v30 offset:41984
    s_xor_b32 s56, s56, 0
    v_xor_b32 v5, s56, v25
    v_mfma_f32_32x32x16_bf16 v[104:119], a[4:7], a[24:27], v[104:119]
    buffer_load_dwordx4 v12, s[8:11], s45 offen offset:1024  lds
    ds_read_b128 a[12:15], v39 offset:16384
    ds_read_b128 a[16:19], v39 offset:20480
    v_lshlrev_b32 v5, 6, v5
    v_lshl_add_u32 v5, v25, 8, v5
    s_waitcnt lgkmcnt(4)
    v_mfma_f32_32x32x16_bf16 v[88:103], a[8:11], a[28:31], v[88:103]
    s_add_u32 m0, s44, 49152
    s_add_u32 s46, s46, 262144
    s_and_b32 s46, s46, 0x7fffff
    buffer_load_dwordx4 v13, s[20:23], s46 offen  lds
    ds_read_b64_tr_b16 a[4:5], v30 offset:45056
    ds_read_b64_tr_b16 a[6:7], v30 offset:46080
    v_lshl_add_u32 v5, v28, 10, v5
    v_lshl_add_u32 v5, v27, 5, v5
    v_mfma_f32_32x32x16_bf16 v[104:119], a[8:11], a[32:35], v[104:119]
    buffer_load_dwordx4 v14, s[20:23], s46 offen offset:1024  lds
    ds_read_b128 a[20:23], v42 offset:16384
    ds_read_b128 a[24:27], v42 offset:20480
    v_add_u32 v5, v5, v26
    s_lshl_b32 s56, s43, 13
    s_waitcnt vmcnt(16)
    s_barrier
    s_waitcnt lgkmcnt(4)
    v_mfma_f32_32x32x16_bf16 v[88:103], a[0:3], a[12:15], v[88:103]
    s_add_u32 m0, s44, 57344
    s_add_u32 s46, s46, 262144
    s_and_b32 s46, s46, 0x7fffff
    buffer_load_dwordx4 v13, s[20:23], s46 offen  lds
    ds_read_b64_tr_b16 a[8:9], v30 offset:49152
    ds_read_b64_tr_b16 a[10:11], v30 offset:50176
    v_add_u32 v74, s56, v5
    v_add_u32 v75, 0x10000, v74
    v_mfma_f32_32x32x16_bf16 v[104:119], a[0:3], a[16:19], v[104:119]
    buffer_load_dwordx4 v14, s[20:23], s46 offen offset:1024  lds
    ds_read_b128 a[28:31], v33 offset:24576
    ds_read_b128 a[32:35], v33 offset:28672
    v_add_u32 v76, 0x20000, v74
    s_lshl_b32 s56, s43, 1
    s_waitcnt lgkmcnt(4)
    v_mfma_f32_32x32x16_bf16 v[88:103], a[4:7], a[20:23], v[88:103]
    s_add_u32 m0, s44, 24576
    s_add_u32 s45, s45, 128
    s_and_b32 s45, s45, 2047
    buffer_load_dwordx4 v11, s[8:11], s45 offen  lds
    ds_read_b64_tr_b16 a[0:1], v30 offset:53248
    ds_read_b64_tr_b16 a[2:3], v30 offset:54272
    s_xor_b32 s56, s56, 1
    v_xor_b32 v5, s56, v25
    v_mfma_f32_32x32x16_bf16 v[104:119], a[4:7], a[24:27], v[104:119]
    buffer_load_dwordx4 v12, s[8:11], s45 offen offset:1024  lds
    ds_read_b128 a[12:15], v36 offset:24576
    ds_read_b128 a[16:19], v36 offset:28672
    v_lshlrev_b32 v5, 6, v5
    v_lshl_add_u32 v5, v25, 8, v5
    s_waitcnt lgkmcnt(4)
    v_mfma_f32_32x32x16_bf16 v[88:103], a[8:11], a[28:31], v[88:103]
    s_add_u32 m0, s44, 65536
    s_add_u32 s46, s46, 262144
    s_and_b32 s46, s46, 0x7fffff
    buffer_load_dwordx4 v13, s[20:23], s46 offen  lds
    ds_read_b64_tr_b16 a[4:5], v30 offset:57344
    ds_read_b64_tr_b16 a[6:7], v30 offset:58368
    v_lshl_add_u32 v5, v28, 10, v5
    v_lshl_add_u32 v5, v27, 5, v5
    v_mfma_f32_32x32x16_bf16 v[104:119], a[8:11], a[32:35], v[104:119]
    buffer_load_dwordx4 v14, s[20:23], s46 offen offset:1024  lds
    ds_read_b128 a[20:23], v39 offset:24576
    ds_read_b128 a[24:27], v39 offset:28672
    v_add_u32 v5, v5, v26
    s_lshl_b32 s56, s43, 13
    s_waitcnt lgkmcnt(4)
    v_mfma_f32_32x32x16_bf16 v[88:103], a[0:3], a[12:15], v[88:103]
    s_add_u32 m0, s44, 73728
    s_add_u32 s46, s46, 262144
    s_and_b32 s46, s46, 0x7fffff
    buffer_load_dwordx4 v13, s[20:23], s46 offen  lds
    ds_read_b64_tr_b16 a[8:9], v30 offset:61440
    ds_read_b64_tr_b16 a[10:11], v30 offset:62464
    v_add_u32 v77, s56, v5
    v_add_u32 v78, 0x10000, v77
    v_mfma_f32_32x32x16_bf16 v[104:119], a[0:3], a[16:19], v[104:119]
    buffer_load_dwordx4 v14, s[20:23], s46 offen offset:1024  lds
    ds_read_b128 a[28:31], v42 offset:24576
    ds_read_b128 a[32:35], v42 offset:28672
    v_add_u32 v79, 0x20000, v77
    s_lshl_b32 s56, s43, 1
    s_waitcnt vmcnt(18)
    s_barrier
    s_waitcnt lgkmcnt(4)
    v_mfma_f32_32x32x16_bf16 v[88:103], a[4:7], a[20:23], v[88:103]
    s_add_u32 m0, s44, 32768
    s_add_u32 s45, s45, 128
    s_and_b32 s45, s45, 2047
    buffer_load_dwordx4 v11, s[8:11], s45 offen  lds
    ds_read_b64_tr_b16 a[0:1], v31 offset:0
    ds_read_b64_tr_b16 a[2:3], v31 offset:1024
    s_xor_b32 s56, s56, 2
    v_xor_b32 v5, s56, v25
    v_mfma_f32_32x32x16_bf16 v[104:119], a[4:7], a[24:27], v[104:119]
    buffer_load_dwordx4 v12, s[8:11], s45 offen offset:1024  lds
    ds_read_b128 a[12:15], v34 offset:16384
    ds_read_b128 a[16:19], v34 offset:20480
    v_lshlrev_b32 v5, 6, v5
    v_lshl_add_u32 v5, v25, 8, v5
    s_waitcnt lgkmcnt(4)
    v_mfma_f32_32x32x16_bf16 v[88:103], a[8:11], a[28:31], v[88:103]
    s_add_u32 m0, s44, 98304
    s_add_u32 s46, s46, 262144
    s_and_b32 s46, s46, 0x7fffff
    buffer_load_dwordx4 v13, s[20:23], s46 offen  lds
    ds_read_b64_tr_b16 a[4:5], v31 offset:4096
    ds_read_b64_tr_b16 a[6:7], v31 offset:5120
    v_lshl_add_u32 v5, v28, 10, v5
    v_lshl_add_u32 v5, v27, 5, v5
    v_mfma_f32_32x32x16_bf16 v[104:119], a[8:11], a[32:35], v[104:119]
    buffer_load_dwordx4 v14, s[20:23], s46 offen offset:1024  lds
    ds_read_b128 a[20:23], v37 offset:16384
    ds_read_b128 a[24:27], v37 offset:20480
    v_add_u32 v5, v5, v26
    s_lshl_b32 s56, s43, 13
    s_waitcnt lgkmcnt(4)
    v_mfma_f32_32x32x16_bf16 v[88:103], a[0:3], a[12:15], v[88:103]
    s_add_u32 m0, s44, 106496
    s_add_u32 s46, s46, 262144
    s_and_b32 s46, s46, 0x7fffff
    buffer_load_dwordx4 v13, s[20:23], s46 offen  lds
    ds_read_b64_tr_b16 a[8:9], v31 offset:8192
    ds_read_b64_tr_b16 a[10:11], v31 offset:9216
    v_add_u32 v80, s56, v5
    v_add_u32 v81, 0x10000, v80
    v_mfma_f32_32x32x16_bf16 v[104:119], a[0:3], a[16:19], v[104:119]
    buffer_load_dwordx4 v14, s[20:23], s46 offen offset:1024  lds
    ds_read_b128 a[28:31], v40 offset:16384
    ds_read_b128 a[32:35], v40 offset:20480
    v_add_u32 v82, 0x20000, v80
    s_lshl_b32 s56, s43, 1
    s_waitcnt lgkmcnt(4)
    v_mfma_f32_32x32x16_bf16 v[88:103], a[4:7], a[20:23], v[88:103]
    s_add_u32 m0, s44, 40960
    s_add_u32 s45, s45, 128
    s_and_b32 s45, s45, 2047
    buffer_load_dwordx4 v11, s[8:11], s45 offen  lds
    ds_read_b64_tr_b16 a[0:1], v31 offset:12288
    ds_read_b64_tr_b16 a[2:3], v31 offset:13312
    s_xor_b32 s56, s56, 3
    v_xor_b32 v5, s56, v25
    v_mfma_f32_32x32x16_bf16 v[104:119], a[4:7], a[24:27], v[104:119]
    buffer_load_dwordx4 v12, s[8:11], s45 offen offset:1024  lds
    ds_read_b128 a[12:15], v43 offset:16384
    ds_read_b128 a[16:19], v43 offset:20480
    v_lshlrev_b32 v5, 6, v5
    v_lshl_add_u32 v5, v25, 8, v5
    s_waitcnt vmcnt(20)
    s_barrier
    s_waitcnt lgkmcnt(4)
    v_mfma_f32_32x32x16_bf16 v[88:103], a[8:11], a[28:31], v[88:103]
    s_add_u32 m0, s44, 114688
    s_add_u32 s46, s46, 262144
    s_and_b32 s46, s46, 0x7fffff
    buffer_load_dwordx4 v13, s[20:23], s46 offen  lds
    ds_read_b64_tr_b16 a[4:5], v29 offset:0
    ds_read_b64_tr_b16 a[6:7], v29 offset:1024
    v_lshl_add_u32 v5, v28, 10, v5
    v_lshl_add_u32 v5, v27, 5, v5
    v_mfma_f32_32x32x16_bf16 v[104:119], a[8:11], a[32:35], v[104:119]
    buffer_load_dwordx4 v14, s[20:23], s46 offen offset:1024  lds
    ds_read_b128 a[20:23], v34 offset:24576
    ds_read_b128 a[24:27], v34 offset:28672
    v_add_u32 v5, v5, v26
    s_lshl_b32 s56, s43, 13
    s_waitcnt lgkmcnt(4)
    v_mfma_f32_32x32x16_bf16 v[88:103], a[0:3], a[12:15], v[88:103]
    s_add_u32 m0, s44, 122880
    s_add_u32 s46, s46, 262144
    s_and_b32 s46, s46, 0x7fffff
    buffer_load_dwordx4 v13, s[20:23], s46 offen  lds
    ds_read_b64_tr_b16 a[8:9], v29 offset:4096
    ds_read_b64_tr_b16 a[10:11], v29 offset:5120
    v_add_u32 v83, s56, v5
    v_add_u32 v84, 0x10000, v83
    v_mfma_f32_32x32x16_bf16 v[104:119], a[0:3], a[16:19], v[104:119]
    buffer_load_dwordx4 v14, s[20:23], s46 offen offset:1024  lds
    ds_read_b128 a[28:31], v37 offset:24576
    ds_read_b128 a[32:35], v37 offset:28672
    v_add_u32 v85, 0x20000, v83
    s_lshl_b32 s56, s42, 13
    s_waitcnt lgkmcnt(4)
    v_mfma_f32_32x32x16_bf16 v[88:103], a[4:7], a[20:23], v[88:103]
    s_add_u32 m0, s44, 81920
    s_add_u32 s45, s45, 128
    s_and_b32 s45, s45, 2047
    buffer_load_dwordx4 v11, s[8:11], s45 offen  lds
    ds_read_b64_tr_b16 a[0:1], v29 offset:8192
    ds_read_b64_tr_b16 a[2:3], v29 offset:9216
    s_add_u32 s56, s56, 0x20000
    v_add_u32 v49, s56, v23
    v_mfma_f32_32x32x16_bf16 v[104:119], a[4:7], a[24:27], v[104:119]
    buffer_load_dwordx4 v12, s[8:11], s45 offen offset:1024  lds
    ds_read_b128 a[12:15], v40 offset:24576
    ds_read_b128 a[16:19], v40 offset:28672
    s_lshl_b32 s61, s2, 13
    s_add_u32 s61, s61, 1048576
    s_waitcnt lgkmcnt(4)
    v_mfma_f32_32x32x16_bf16 v[88:103], a[8:11], a[28:31], v[88:103]
    ds_read_b64_tr_b16 a[4:5], v29 offset:12288
    ds_read_b64_tr_b16 a[6:7], v29 offset:13312
    v_mfma_f32_32x32x16_bf16 v[104:119], a[8:11], a[32:35], v[104:119]
    ds_read_b128 a[20:23], v43 offset:24576
    ds_read_b128 a[24:27], v43 offset:28672
    s_waitcnt vmcnt(20)
    s_barrier
    s_waitcnt lgkmcnt(4)
    v_mfma_f32_32x32x16_bf16 v[88:103], a[0:3], a[12:15], v[88:103]
    s_add_u32 m0, s44, 131072
    s_add_u32 s46, s46, 262144
    s_and_b32 s46, s46, 0x7fffff
    buffer_load_dwordx4 v13, s[20:23], s46 offen  lds
    ds_read_b64_tr_b16 a[8:9], v29 offset:49152
    ds_read_b64_tr_b16 a[10:11], v29 offset:50176
    v_mfma_f32_32x32x16_bf16 v[104:119], a[0:3], a[16:19], v[104:119]
    buffer_load_dwordx4 v14, s[20:23], s46 offen offset:1024  lds
    ds_read_b128 a[28:31], v32 offset:16384
    ds_read_b128 a[32:35], v32 offset:20480
    s_waitcnt lgkmcnt(4)
    v_mfma_f32_32x32x16_bf16 v[88:103], a[4:7], a[20:23], v[88:103]
    s_add_u32 m0, s44, 139264
    s_add_u32 s46, s46, 262144
    s_and_b32 s46, s46, 0x7fffff
    buffer_load_dwordx4 v13, s[20:23], s46 offen  lds
    ds_read_b64_tr_b16 a[0:1], v29 offset:53248
    ds_read_b64_tr_b16 a[2:3], v29 offset:54272
    v_mfma_f32_32x32x16_bf16 v[104:119], a[4:7], a[24:27], v[104:119]
    buffer_load_dwordx4 v14, s[20:23], s46 offen offset:1024  lds
    ds_read_b128 a[12:15], v35 offset:16384
    ds_read_b128 a[16:19], v35 offset:20480
    s_waitcnt lgkmcnt(4)
    v_mfma_f32_32x32x16_bf16 v[88:103], a[8:11], a[28:31], v[88:103]
    s_add_u32 m0, s44, 90112
    s_add_u32 s45, s45, 128
    s_and_b32 s45, s45, 2047
    buffer_load_dwordx4 v11, s[8:11], s45 offen  lds
    ds_read_b64_tr_b16 a[4:5], v29 offset:57344
    ds_read_b64_tr_b16 a[6:7], v29 offset:58368
    v_mfma_f32_32x32x16_bf16 v[104:119], a[8:11], a[32:35], v[104:119]
    buffer_load_dwordx4 v12, s[8:11], s45 offen offset:1024  lds
    ds_read_b128 a[20:23], v38 offset:16384
    ds_read_b128 a[24:27], v38 offset:20480
    s_waitcnt lgkmcnt(4)
    v_mfma_f32_32x32x16_bf16 v[88:103], a[0:3], a[12:15], v[88:103]
    ds_read_b64_tr_b16 a[8:9], v29 offset:61440
    ds_read_b64_tr_b16 a[10:11], v29 offset:62464
    v_mfma_f32_32x32x16_bf16 v[104:119], a[0:3], a[16:19], v[104:119]
    ds_read_b128 a[28:31], v41 offset:16384
    ds_read_b128 a[32:35], v41 offset:20480
    s_waitcnt vmcnt(20)
    s_barrier
    s_waitcnt lgkmcnt(4)
    v_mfma_f32_32x32x16_bf16 v[88:103], a[4:7], a[20:23], v[88:103]
    s_add_u32 m0, s44, 0
    s_add_u32 s46, s46, 262144
    s_and_b32 s46, s46, 0x7fffff
    buffer_load_dwordx4 v13, s[20:23], s46 offen  lds
    ds_read_b64_tr_b16 a[0:1], v30 offset:0
    ds_read_b64_tr_b16 a[2:3], v30 offset:1024
    v_mfma_f32_32x32x16_bf16 v[104:119], a[4:7], a[24:27], v[104:119]
    buffer_load_dwordx4 v14, s[20:23], s46 offen offset:1024  lds
    ds_read_b128 a[12:15], v32 offset:24576
    ds_read_b128 a[16:19], v32 offset:28672
    s_waitcnt lgkmcnt(4)
    v_mfma_f32_32x32x16_bf16 v[88:103], a[8:11], a[28:31], v[88:103]
    s_add_u32 m0, s44, 8192
    s_add_u32 s46, s46, 262144
    s_and_b32 s46, s46, 0x7fffff
    buffer_load_dwordx4 v13, s[20:23], s46 offen  lds
    ds_read_b64_tr_b16 a[4:5], v30 offset:4096
    ds_read_b64_tr_b16 a[6:7], v30 offset:5120
    v_mfma_f32_32x32x16_bf16 v[104:119], a[8:11], a[32:35], v[104:119]
    buffer_load_dwordx4 v14, s[20:23], s46 offen offset:1024  lds
    ds_read_b128 a[20:23], v35 offset:24576
    ds_read_b128 a[24:27], v35 offset:28672
    s_waitcnt lgkmcnt(4)
    v_mfma_f32_32x32x16_bf16 v[88:103], a[0:3], a[12:15], v[88:103]
    ds_read_b64_tr_b16 a[8:9], v30 offset:8192
    ds_read_b64_tr_b16 a[10:11], v30 offset:9216
    v_mfma_f32_32x32x16_bf16 v[104:119], a[0:3], a[16:19], v[104:119]
    ds_read_b128 a[28:31], v38 offset:24576
    ds_read_b128 a[32:35], v38 offset:28672
    s_waitcnt lgkmcnt(4)
    v_mfma_f32_32x32x16_bf16 v[88:103], a[4:7], a[20:23], v[88:103]
    ds_read_b64_tr_b16 a[0:1], v30 offset:12288
    ds_read_b64_tr_b16 a[2:3], v30 offset:13312
    v_mfma_f32_32x32x16_bf16 v[104:119], a[4:7], a[24:27], v[104:119]
    ds_read_b128 a[12:15], v41 offset:24576
    ds_read_b128 a[16:19], v41 offset:28672
    s_waitcnt vmcnt(18)
    s_barrier
    s_waitcnt lgkmcnt(4)
    v_mfma_f32_32x32x16_bf16 v[88:103], a[8:11], a[28:31], v[88:103]
    s_add_u32 m0, s44, 49152
    s_add_u32 s45, s45, 128
    s_and_b32 s45, s45, 2047
    buffer_load_dwordx4 v11, s[8:11], s45 offen  lds
    ds_read_b64_tr_b16 a[4:5], v30 offset:32768
    ds_read_b64_tr_b16 a[6:7], v30 offset:33792
    v_mfma_f32_32x32x16_bf16 v[104:119], a[8:11], a[32:35], v[104:119]
    buffer_load_dwordx4 v12, s[8:11], s45 offen offset:1024  lds
    ds_read_b128 a[20:23], v32 offset:32768
    ds_read_b128 a[24:27], v32 offset:36864
    s_waitcnt lgkmcnt(4)
    v_mfma_f32_32x32x16_bf16 v[88:103], a[0:3], a[12:15], v[88:103]
    ds_read_b64_tr_b16 a[8:9], v30 offset:36864
    ds_read_b64_tr_b16 a[10:11], v30 offset:37888
    v_mfma_f32_32x32x16_bf16 v[104:119], a[0:3], a[16:19], v[104:119]
    ds_read_b128 a[28:31], v35 offset:32768
    ds_read_b128 a[32:35], v35 offset:36864
    s_waitcnt lgkmcnt(4)
    v_mfma_f32_32x32x16_bf16 v[88:103], a[4:7], a[20:23], v[88:103]
    ds_read_b64_tr_b16 a[0:1], v30 offset:40960
    ds_read_b64_tr_b16 a[2:3], v30 offset:41984
    v_mfma_f32_32x32x16_bf16 v[104:119], a[4:7], a[24:27], v[104:119]
    ds_read_b128 a[12:15], v38 offset:32768
    ds_read_b128 a[16:19], v38 offset:36864
    s_waitcnt lgkmcnt(4)
    v_mfma_f32_32x32x16_bf16 v[88:103], a[8:11], a[28:31], v[88:103]
    ds_read_b64_tr_b16 a[4:5], v30 offset:45056
    ds_read_b64_tr_b16 a[6:7], v30 offset:46080
    v_mfma_f32_32x32x16_bf16 v[104:119], a[8:11], a[32:35], v[104:119]
    ds_read_b128 a[20:23], v41 offset:32768
    ds_read_b128 a[24:27], v41 offset:36864
    s_waitcnt vmcnt(14)
    s_barrier
    buffer_load_dword v87, v248, s[32:35], 0 offen sc1
    s_waitcnt lgkmcnt(4)
    v_mfma_f32_32x32x16_bf16 v[88:103], a[0:3], a[12:15], v[88:103]
    s_add_u32 m0, s44, 65536
    s_add_u32 s46, s46, 262144
    s_and_b32 s46, s46, 0x7fffff
    buffer_load_dwordx4 v13, s[20:23], s46 offen  lds
    ds_read_b64_tr_b16 a[8:9], v30 offset:49152
    ds_read_b64_tr_b16 a[10:11], v30 offset:50176
    v_mfma_f32_32x32x16_bf16 v[104:119], a[0:3], a[16:19], v[104:119]
    buffer_load_dwordx4 v14, s[20:23], s46 offen offset:1024  lds
    ds_read_b128 a[28:31], v32 offset:40960
    ds_read_b128 a[32:35], v32 offset:45056
    s_waitcnt lgkmcnt(4)
    v_mfma_f32_32x32x16_bf16 v[88:103], a[4:7], a[20:23], v[88:103]
    s_add_u32 m0, s44, 73728
    s_add_u32 s46, s46, 262144
    s_and_b32 s46, s46, 0x7fffff
    buffer_load_dwordx4 v13, s[20:23], s46 offen  lds
    ds_read_b64_tr_b16 a[0:1], v30 offset:53248
    ds_read_b64_tr_b16 a[2:3], v30 offset:54272
    v_mfma_f32_32x32x16_bf16 v[104:119], a[4:7], a[24:27], v[104:119]
    buffer_load_dwordx4 v14, s[20:23], s46 offen offset:1024  lds
    ds_read_b128 a[12:15], v35 offset:40960
    ds_read_b128 a[16:19], v35 offset:45056
    s_waitcnt lgkmcnt(4)
    v_mfma_f32_32x32x16_bf16 v[88:103], a[8:11], a[28:31], v[88:103]
    s_add_u32 m0, s44, 57344
    s_add_u32 s45, s45, 128
    s_and_b32 s45, s45, 2047
    buffer_load_dwordx4 v11, s[8:11], s45 offen  lds
    ds_read_b64_tr_b16 a[4:5], v30 offset:57344
    ds_read_b64_tr_b16 a[6:7], v30 offset:58368
    v_mfma_f32_32x32x16_bf16 v[104:119], a[8:11], a[32:35], v[104:119]
    buffer_load_dwordx4 v12, s[8:11], s45 offen offset:1024  lds
    ds_read_b128 a[20:23], v38 offset:40960
    ds_read_b128 a[24:27], v38 offset:45056
    s_waitcnt lgkmcnt(4)
    v_mfma_f32_32x32x16_bf16 v[88:103], a[0:3], a[12:15], v[88:103]
    s_add_u32 m0, s44, 16384
    s_add_u32 s46, s46, 262144
    s_and_b32 s46, s46, 0x7fffff
    buffer_load_dwordx4 v13, s[20:23], s46 offen  lds
    ds_read_b64_tr_b16 a[8:9], v30 offset:61440
    ds_read_b64_tr_b16 a[10:11], v30 offset:62464
    v_mfma_f32_32x32x16_bf16 v[104:119], a[0:3], a[16:19], v[104:119]
    buffer_load_dwordx4 v14, s[20:23], s46 offen offset:1024  lds
    ds_read_b128 a[28:31], v41 offset:40960
    ds_read_b128 a[32:35], v41 offset:45056
    s_waitcnt vmcnt(17)
    s_barrier
    s_waitcnt lgkmcnt(4)
    v_mfma_f32_32x32x16_bf16 v[88:103], a[4:7], a[20:23], v[88:103]
    s_add_u32 m0, s44, 24576
    s_add_u32 s46, s46, 262144
    s_and_b32 s46, s46, 0x7fffff
    buffer_load_dwordx4 v13, s[20:23], s46 offen  lds
    ds_read_b64_tr_b16 a[0:1], v31 offset:0
    ds_read_b64_tr_b16 a[2:3], v31 offset:1024
    v_mfma_f32_32x32x16_bf16 v[104:119], a[4:7], a[24:27], v[104:119]
    buffer_load_dwordx4 v14, s[20:23], s46 offen offset:1024  lds
    ds_read_b128 a[12:15], v33 offset:16384
    ds_read_b128 a[16:19], v33 offset:20480
    s_waitcnt lgkmcnt(4)
    v_mfma_f32_32x32x16_bf16 v[88:103], a[8:11], a[28:31], v[88:103]
    s_add_u32 m0, s44, 98304
    s_add_u32 s47, s47, 8192
    s_and_b32 s47, s47, 0xffff
    buffer_load_dwordx4 v17, s[12:15], s47 offen  lds
    ds_read_b64_tr_b16 a[4:5], v31 offset:4096
    ds_read_b64_tr_b16 a[6:7], v31 offset:5120
    v_mfma_f32_32x32x16_bf16 v[104:119], a[8:11], a[32:35], v[104:119]
    buffer_load_dwordx4 v18, s[12:15], s47 offen offset:1024  lds
    ds_read_b128 a[20:23], v36 offset:16384
    ds_read_b128 a[24:27], v36 offset:20480
    s_waitcnt lgkmcnt(4)
    v_mfma_f32_32x32x16_bf16 v[88:103], a[0:3], a[12:15], v[88:103]
    s_add_u32 m0, s44, 106496
    s_add_u32 s51, s47, 65536
    buffer_load_dwordx4 v17, s[12:15], s51 offen  lds
    ds_read_b64_tr_b16 a[8:9], v31 offset:8192
    ds_read_b64_tr_b16 a[10:11], v31 offset:9216
    v_mfma_f32_32x32x16_bf16 v[104:119], a[0:3], a[16:19], v[104:119]
    buffer_load_dwordx4 v18, s[12:15], s51 offen offset:1024  lds
    ds_read_b128 a[28:31], v39 offset:16384
    ds_read_b128 a[32:35], v39 offset:20480
    s_waitcnt lgkmcnt(4)
    v_mfma_f32_32x32x16_bf16 v[88:103], a[4:7], a[20:23], v[88:103]
    ds_read_b64_tr_b16 a[0:1], v31 offset:12288
    ds_read_b64_tr_b16 a[2:3], v31 offset:13312
    v_mfma_f32_32x32x16_bf16 v[104:119], a[4:7], a[24:27], v[104:119]
    ds_read_b128 a[12:15], v42 offset:16384
    ds_read_b128 a[16:19], v42 offset:20480
    s_waitcnt vmcnt(17)
    s_barrier
    s_waitcnt lgkmcnt(4)
    v_mfma_f32_32x32x16_bf16 v[88:103], a[8:11], a[28:31], v[88:103]
    s_add_u32 m0, s44, 114688
    s_add_u32 s47, s47, 8192
    s_and_b32 s47, s47, 0xffff
    buffer_load_dwordx4 v17, s[12:15], s47 offen  lds
    ds_read_b64_tr_b16 a[4:5], v29 offset:0
    ds_read_b64_tr_b16 a[6:7], v29 offset:1024
    v_mfma_f32_32x32x16_bf16 v[104:119], a[8:11], a[32:35], v[104:119]
    buffer_load_dwordx4 v18, s[12:15], s47 offen offset:1024  lds
    ds_read_b128 a[20:23], v33 offset:24576
    ds_read_b128 a[24:27], v33 offset:28672
    s_waitcnt lgkmcnt(4)
    v_mfma_f32_32x32x16_bf16 v[88:103], a[0:3], a[12:15], v[88:103]
    s_add_u32 m0, s44, 122880
    s_add_u32 s51, s47, 65536
    buffer_load_dwordx4 v17, s[12:15], s51 offen  lds
    ds_read_b64_tr_b16 a[8:9], v29 offset:4096
    ds_read_b64_tr_b16 a[10:11], v29 offset:5120
    v_mfma_f32_32x32x16_bf16 v[104:119], a[0:3], a[16:19], v[104:119]
    buffer_load_dwordx4 v18, s[12:15], s51 offen offset:1024  lds
    ds_read_b128 a[28:31], v36 offset:24576
    ds_read_b128 a[32:35], v36 offset:28672
    s_waitcnt lgkmcnt(4)
    v_mfma_f32_32x32x16_bf16 v[88:103], a[4:7], a[20:23], v[88:103]
    ds_read_b64_tr_b16 a[0:1], v29 offset:8192
    ds_read_b64_tr_b16 a[2:3], v29 offset:9216
    v_mfma_f32_32x32x16_bf16 v[104:119], a[4:7], a[24:27], v[104:119]
    ds_read_b128 a[12:15], v39 offset:24576
    ds_read_b128 a[16:19], v39 offset:28672
    s_waitcnt lgkmcnt(4)
    v_mfma_f32_32x32x16_bf16 v[88:103], a[8:11], a[28:31], v[88:103]
    ds_read_b64_tr_b16 a[4:5], v29 offset:12288
    ds_read_b64_tr_b16 a[6:7], v29 offset:13312
    v_mfma_f32_32x32x16_bf16 v[104:119], a[8:11], a[32:35], v[104:119]
    ds_read_b128 a[20:23], v42 offset:24576
    ds_read_b128 a[24:27], v42 offset:28672
    s_waitcnt vmcnt(14)
    s_barrier
    v_cmp_eq_u32 vcc, s93, v87
    s_nop 4
    s_cmp_eq_u64 vcc, -1
    s_cselect_b32 s92, 1, 0
    s_waitcnt lgkmcnt(4)
    v_mfma_f32_32x32x16_bf16 v[88:103], a[0:3], a[12:15], v[88:103]
    ds_read_b64_tr_b16 a[8:9], v30 offset:0
    ds_read_b64_tr_b16 a[10:11], v30 offset:1024
    v_mfma_f32_32x32x16_bf16 v[104:119], a[0:3], a[16:19], v[104:119]
    ds_read_b128 a[28:31], v32 offset:49152
    ds_read_b128 a[32:35], v32 offset:53248
    s_waitcnt lgkmcnt(4)
    v_mfma_f32_32x32x16_bf16 v[88:103], a[4:7], a[20:23], v[88:103]
    ds_read_b64_tr_b16 a[0:1], v30 offset:4096
    ds_read_b64_tr_b16 a[2:3], v30 offset:5120
    v_mfma_f32_32x32x16_bf16 v[104:119], a[4:7], a[24:27], v[104:119]
    ds_read_b128 a[12:15], v35 offset:49152
    ds_read_b128 a[16:19], v35 offset:53248
    s_waitcnt lgkmcnt(4)
    v_mfma_f32_32x32x16_bf16 v[88:103], a[8:11], a[28:31], v[88:103]
    ds_read_b64_tr_b16 a[4:5], v30 offset:8192
    ds_read_b64_tr_b16 a[6:7], v30 offset:9216
    v_mfma_f32_32x32x16_bf16 v[104:119], a[8:11], a[32:35], v[104:119]
    ds_read_b128 a[20:23], v38 offset:49152
    ds_read_b128 a[24:27], v38 offset:53248
    s_waitcnt lgkmcnt(4)
    v_mfma_f32_32x32x16_bf16 v[88:103], a[0:3], a[12:15], v[88:103]
    ds_read_b64_tr_b16 a[8:9], v30 offset:12288
    ds_read_b64_tr_b16 a[10:11], v30 offset:13312
    v_mfma_f32_32x32x16_bf16 v[104:119], a[0:3], a[16:19], v[104:119]
    ds_read_b128 a[28:31], v41 offset:49152
    ds_read_b128 a[32:35], v41 offset:53248
    s_waitcnt vmcnt(8)
    s_barrier
    s_waitcnt lgkmcnt(4)
    v_mfma_f32_32x32x16_bf16 v[88:103], a[4:7], a[20:23], v[88:103]
    ds_read_b64_tr_b16 a[0:1], v29 offset:16384
    ds_read_b64_tr_b16 a[2:3], v29 offset:17408
    v_mfma_f32_32x32x16_bf16 v[104:119], a[4:7], a[24:27], v[104:119]
    ds_read_b128 a[12:15], v32 offset:57344
    ds_read_b128 a[16:19], v32 offset:61440
    s_waitcnt lgkmcnt(4)
    v_mfma_f32_32x32x16_bf16 v[88:103], a[8:11], a[28:31], v[88:103]
    ds_read_b64_tr_b16 a[4:5], v29 offset:20480
    ds_read_b64_tr_b16 a[6:7], v29 offset:21504
    v_mfma_f32_32x32x16_bf16 v[104:119], a[8:11], a[32:35], v[104:119]
    ds_read_b128 a[20:23], v35 offset:57344
    ds_read_b128 a[24:27], v35 offset:61440
    s_waitcnt lgkmcnt(4)
    v_mfma_f32_32x32x16_bf16 v[88:103], a[0:3], a[12:15], v[88:103]
    ds_read_b64_tr_b16 a[8:9], v29 offset:24576
    ds_read_b64_tr_b16 a[10:11], v29 offset:25600
    v_mfma_f32_32x32x16_bf16 v[104:119], a[0:3], a[16:19], v[104:119]
    ds_read_b128 a[28:31], v38 offset:57344
    ds_read_b128 a[32:35], v38 offset:61440
    s_waitcnt lgkmcnt(4)
    v_mfma_f32_32x32x16_bf16 v[88:103], a[4:7], a[20:23], v[88:103]
    ds_read_b64_tr_b16 a[0:1], v29 offset:28672
    ds_read_b64_tr_b16 a[2:3], v29 offset:29696
    v_mfma_f32_32x32x16_bf16 v[104:119], a[4:7], a[24:27], v[104:119]
    ds_read_b128 a[12:15], v41 offset:57344
    ds_read_b128 a[16:19], v41 offset:61440
    s_barrier
    s_waitcnt lgkmcnt(4)
    v_mfma_f32_32x32x16_bf16 v[88:103], a[8:11], a[28:31], v[88:103]
    v_mfma_f32_32x32x16_bf16 v[104:119], a[8:11], a[32:35], v[104:119]
    s_waitcnt lgkmcnt(0)
    v_mfma_f32_32x32x16_bf16 v[88:103], a[0:3], a[12:15], v[88:103]
    v_mfma_f32_32x32x16_bf16 v[104:119], a[0:3], a[16:19], v[104:119]
    s_barrier
    s_nop 10
    v_cvt_pk_bf16_f32 v128, v104, v105
    v_cvt_pk_bf16_f32 v129, v106, v107
    v_cvt_pk_bf16_f32 v130, v108, v109
    v_cvt_pk_bf16_f32 v131, v110, v111
    v_cvt_pk_bf16_f32 v132, v112, v113
    v_cvt_pk_bf16_f32 v133, v114, v115
    v_cvt_pk_bf16_f32 v134, v116, v117
    v_cvt_pk_bf16_f32 v135, v118, v119
    s_cmp_eq_u32 s92, 1
    s_cbranch_scc0 L_slow_1
    buffer_store_dwordx4 v[128:131], v22, s[32:35], s61 offen offset:0
    buffer_store_dwordx4 v[132:135], v22, s[32:35], s61 offen offset:1024
    s_branch L_stored_2
L_slow_1:
    buffer_store_dwordx4 v[128:131], v22, s[32:35], s61 offen offset:0 sc1
    buffer_store_dwordx4 v[132:135], v22, s[32:35], s61 offen offset:1024 sc1
L_stored_2:
    v_cvt_pk_bf16_f32 v120, v88, v89
    v_cvt_pk_bf16_f32 v121, v90, v91
    v_cvt_pk_bf16_f32 v122, v92, v93
    v_cvt_pk_bf16_f32 v123, v94, v95
    v_cvt_pk_bf16_f32 v124, v96, v97
    v_cvt_pk_bf16_f32 v125, v98, v99
    v_cvt_pk_bf16_f32 v126, v100, v101
    v_cvt_pk_bf16_f32 v127, v102, v103
    ds_write_b128 v48, v[120:123] offset:16384
    ds_write_b128 v48, v[124:127] offset:17408
    s_add_u32 m0, s44, 32768
    s_add_u32 s47, s47, 8192
    s_and_b32 s47, s47, 0xffff
    buffer_load_dwordx4 v17, s[12:15], s47 offen  lds
    buffer_load_dwordx4 v18, s[12:15], s47 offen offset:1024  lds
    s_add_u32 m0, s44, 40960
    s_add_u32 s51, s47, 65536
    buffer_load_dwordx4 v17, s[12:15], s51 offen  lds
    buffer_load_dwordx4 v18, s[12:15], s51 offen offset:1024  lds
    s_add_u32 m0, s44, 131072
    s_add_u32 s47, s47, 8192
    s_and_b32 s47, s47, 0xffff
    buffer_load_dwordx4 v17, s[12:15], s47 offen  lds
    buffer_load_dwordx4 v18, s[12:15], s47 offen offset:1024  lds
    s_add_u32 m0, s44, 139264
    s_add_u32 s51, s47, 65536
    buffer_load_dwordx4 v17, s[12:15], s51 offen  lds
    buffer_load_dwordx4 v18, s[12:15], s51 offen offset:1024  lds
    s_add_u32 m0, s44, 0
    s_add_u32 s47, s47, 8192
    s_and_b32 s47, s47, 0xffff
    buffer_load_dwordx4 v17, s[12:15], s47 offen  lds
    buffer_load_dwordx4 v18, s[12:15], s47 offen offset:1024  lds
    s_add_u32 m0, s44, 8192
    s_add_u32 s51, s47, 65536
    buffer_load_dwordx4 v17, s[12:15], s51 offen  lds
    buffer_load_dwordx4 v18, s[12:15], s51 offen offset:1024  lds
    s_waitcnt vmcnt(12)
    s_waitcnt lgkmcnt(0)
    s_barrier
    s_cmp_lg_u32 s39, 0
    s_cbranch_scc1 L_noflag_3
    s_mov_b64 exec, 1
    s_cmp_eq_u32 s92, 1
    s_cbranch_scc0 L_slowf_4
    buffer_store_dword v44, v46, s[32:35], 0 offen
    s_branch L_flagged_5
L_slowf_4:
    buffer_store_dword v44, v46, s[32:35], 0 offen sc1
L_flagged_5:
    s_mov_b64 exec, -1
L_noflag_3:
    s_cmp_lg_u32 s42, 0
    s_cbranch_scc1 L_qremote_6
    ds_read_b128 a[0:3], v49 offset:16384
    ds_read_b128 a[4:7], v49 offset:17408
    ds_read_b128 a[8:11], v49 offset:18432
    ds_read_b128 a[12:15], v49 offset:19456
    ds_read_b128 a[16:19], v49 offset:20480
    ds_read_b128 a[20:23], v49 offset:21504
    ds_read_b128 a[24:27], v49 offset:22528
    ds_read_b128 a[28:31], v49 offset:23552
    s_branch L_qjoin_7
L_qremote_6:
    s_mov_b32 s54, 200000
L_poll_8:
    buffer_load_dword v45, v47, s[32:35], 0 offen sc1
    s_waitcnt vmcnt(0)
    v_cmp_ne_u32 vcc, s52, v45
    s_nop 4
    s_cbranch_vccz L_pdone_9
    s_sub_u32 s54, s54, 1
    s_cbranch_scc0 L_poll_8
L_pdone_9:
    s_xor_b32 s56, s2, 8
    s_lshl_b32 s56, s56, 13
    s_add_u32 s56, s56, 1048576
    s_add_u32 s58, s56, 4096
    buffer_load_dwordx4 a[0:3], v23, s[32:35], s56 offen offset:0 sc1
    buffer_load_dwordx4 a[4:7], v23, s[32:35], s56 offen offset:1024 sc1
    buffer_load_dwordx4 a[8:11], v23, s[32:35], s56 offen offset:2048 sc1
    buffer_load_dwordx4 a[12:15], v23, s[32:35], s56 offen offset:3072 sc1
    buffer_load_dwordx4 a[16:19], v23, s[32:35], s58 offen offset:0 sc1
    buffer_load_dwordx4 a[20:23], v23, s[32:35], s58 offen offset:1024 sc1
    buffer_load_dwordx4 a[24:27], v23, s[32:35], s58 offen offset:2048 sc1
    buffer_load_dwordx4 a[28:31], v23, s[32:35], s58 offen offset:3072 sc1
    s_waitcnt vmcnt(0)
L_qjoin_7:
    s_add_u32 m0, s44, 81920
    s_add_u32 s47, s47, 8192
    s_and_b32 s47, s47, 0xffff
    buffer_load_dwordx4 v17, s[12:15], s47 offen  lds
    buffer_load_dwordx4 v18, s[12:15], s47 offen offset:1024  lds
    s_add_u32 m0, s44, 90112
    s_add_u32 s51, s47, 65536
    buffer_load_dwordx4 v17, s[12:15], s51 offen  lds
    buffer_load_dwordx4 v18, s[12:15], s51 offen offset:1024  lds
    ds_read_b128 a[32:35], v51 offset:32768
    ds_read_b128 a[36:39], v54 offset:32768
    ds_read_b128 a[40:43], v57 offset:32768
    ds_read_b128 a[44:47], v60 offset:32768
    s_mov_b32 s61, 0x3e0293ee
    s_waitcnt lgkmcnt(2)
    v_mfma_f32_32x32x16_bf16 v[88:103], a[32:35], a[0:3], 0
    s_add_u32 m0, s44, 65536
    s_add_u32 s47, s47, 8192
    s_and_b32 s47, s47, 0xffff
    buffer_load_dwordx4 v17, s[12:15], s47 offen  lds
    ds_read_b128 a[48:51], v63 offset:32768
    v_lshlrev_b32 v1, 2, v9
    s_lshl_b32 s58, s39, 9
    v_mfma_f32_32x32x16_bf16 v[88:103], a[36:39], a[4:7], v[88:103]
    buffer_load_dwordx4 v18, s[12:15], s47 offen offset:1024  lds
    ds_read_b128 a[52:55], v66 offset:32768
    s_add_u32 s59, s58, 147456
    v_add_u32 v14, s59, v1
    s_waitcnt lgkmcnt(2)
    v_mfma_f32_32x32x16_bf16 v[88:103], a[40:43], a[8:11], v[88:103]
    s_add_u32 m0, s44, 73728
    s_add_u32 s51, s47, 65536
    buffer_load_dwordx4 v17, s[12:15], s51 offen  lds
    ds_read_b128 a[56:59], v69 offset:32768
    s_xor_b32 s58, s58, 512
    s_add_u32 s59, s58, 147456
    v_mfma_f32_32x32x16_bf16 v[88:103], a[44:47], a[12:15], v[88:103]
    buffer_load_dwordx4 v18, s[12:15], s51 offen offset:1024  lds
    ds_read_b128 a[60:63], v72 offset:32768
    v_add_u32 v24, s59, v1
    s_xor_b32 s56, s37, s42
    s_barrier
    s_waitcnt lgkmcnt(2)
    v_mfma_f32_32x32x16_bf16 v[88:103], a[48:51], a[16:19], v[88:103]
    s_add_u32 m0, s44, 16384
    s_add_u32 s47, s47, 8192
    s_and_b32 s47, s47, 0xffff
    buffer_load_dwordx4 v17, s[12:15], s47 offen  lds
    ds_read_b128 a[32:35], v51 offset:49152
    s_lshl_b32 s56, s56, 1
    s_add_u32 s56, s56, s43
    v_mfma_f32_32x32x16_bf16 v[88:103], a[52:55], a[20:23], v[88:103]
    buffer_load_dwordx4 v18, s[12:15], s47 offen offset:1024  lds
    ds_read_b128 a[36:39], v54 offset:49152
    s_lshl_b32 s56, s56, 13
    s_lshl_b32 s58, s41, 10
    s_waitcnt lgkmcnt(2)
    v_mfma_f32_32x32x16_bf16 v[88:103], a[56:59], a[24:27], v[88:103]
    s_add_u32 m0, s44, 24576
    s_add_u32 s51, s47, 65536
    buffer_load_dwordx4 v17, s[12:15], s51 offen  lds
    ds_read_b128 a[40:43], v57 offset:49152
    s_add_u32 s56, s56, s58
    s_add_u32 s62, s56, 1024
    v_mfma_f32_32x32x16_bf16 v[88:103], a[60:63], a[28:31], v[88:103]
    buffer_load_dwordx4 v18, s[12:15], s51 offen offset:1024  lds
    ds_read_b128 a[44:47], v60 offset:49152
    s_add_u32 s63, s62, 4096
    s_lshl_b32 s56, s2, 7
    s_waitcnt lgkmcnt(2)
    v_mfma_f32_32x32x16_bf16 v[104:119], a[32:35], a[0:3], 0
    s_add_u32 m0, s44, 49152
    s_add_u32 s48, s48, 8192
    s_and_b32 s48, s48, 0xffff
    buffer_load_dwordx4 v19, s[16:19], s48 offen  lds
    ds_read_b128 a[48:51], v63 offset:49152
    s_add_u32 s56, s56, 131072
    v_mov_b32 v29, s56
    v_mfma_f32_32x32x16_bf16 v[104:119], a[36:39], a[4:7], v[104:119]
    buffer_load_dwordx4 v19, s[16:19], s48 offen offset:1024  lds
    ds_read_b128 a[52:55], v66 offset:49152
    s_and_b32 s58, s2, 0xf7
    s_lshl_b32 s58, s58, 7
    s_waitcnt lgkmcnt(2)
    v_mfma_f32_32x32x16_bf16 v[104:119], a[40:43], a[8:11], v[104:119]
    s_add_u32 m0, s44, 57344
    s_add_u32 s51, s48, 65536
    buffer_load_dwordx4 v19, s[16:19], s51 offen  lds
    ds_read_b128 a[56:59], v69 offset:49152
    v_max_f32 v11, v88, v89
    s_add_u32 s58, s58, 131072
    v_mfma_f32_32x32x16_bf16 v[104:119], a[44:47], a[12:15], v[104:119]
    buffer_load_dwordx4 v19, s[16:19], s51 offen offset:1024  lds
    ds_read_b128 a[60:63], v72 offset:49152
    v_max3_f32 v11, v11, v90, v91
    v_and_b32 v1, 1, v9
    s_waitcnt vmcnt(24)
    s_barrier
    s_waitcnt lgkmcnt(2)
    v_mfma_f32_32x32x16_bf16 v[104:119], a[48:51], a[16:19], v[104:119]
    s_add_u32 m0, s44, 98304
    s_add_u32 s48, s48, 8192
    s_and_b32 s48, s48, 0xffff
    buffer_load_dwordx4 v19, s[16:19], s48 offen  lds
    ds_read_b128 a[32:35], v50 offset:32768
    v_max3_f32 v11, v11, v92, v93
    v_lshl_add_u32 v30, v1, 10, s58
    v_mfma_f32_32x32x16_bf16 v[104:119], a[52:55], a[20:23], v[104:119]
    buffer_load_dwordx4 v19, s[16:19], s48 offen offset:1024  lds
    ds_read_b128 a[36:39], v53 offset:32768
    v_max3_f32 v11, v11, v94, v95
    s_and_b32 s58, s2, 0xc7
    s_waitcnt lgkmcnt(2)
    v_mfma_f32_32x32x16_bf16 v[104:119], a[56:59], a[24:27], v[104:119]
    s_add_u32 m0, s44, 106496
    s_add_u32 s51, s48, 65536
    buffer_load_dwordx4 v19, s[16:19], s51 offen  lds
    ds_read_b128 a[40:43], v56 offset:32768
    v_max3_f32 v11, v11, v96, v97
    v_max3_f32 v11, v11, v98, v99
    s_lshl_b32 s58, s58, 7
    v_mfma_f32_32x32x16_bf16 v[104:119], a[60:63], a[28:31], v[104:119]
    buffer_load_dwordx4 v19, s[16:19], s51 offen offset:1024  lds
    ds_read_b128 a[44:47], v59 offset:32768
    v_max3_f32 v11, v11, v100, v101
    v_max3_f32 v11, v11, v102, v103
    s_add_u32 s58, s58, 131072
    v_and_b32 v1, 7, v9
    s_waitcnt lgkmcnt(2)
    v_mfma_f32_32x32x16_bf16 v[120:135], a[32:35], a[0:3], 0
    ds_read_b128 a[48:51], v62 offset:32768
    v_lshl_add_u32 v31, v1, 10, s58
    s_and_b32 s56, s36, 1
    v_mfma_f32_32x32x16_bf16 v[120:135], a[36:39], a[4:7], v[120:135]
    ds_read_b128 a[52:55], v65 offset:32768
    v_xor_b32 v5, s39, v25
    v_lshlrev_b32 v5, 6, v5
    s_waitcnt lgkmcnt(2)
    v_mfma_f32_32x32x16_bf16 v[120:135], a[40:43], a[8:11], v[120:135]
    ds_read_b128 a[56:59], v68 offset:32768
    v_max3_f32 v11, v11, v104, v105
    v_lshl_add_u32 v5, v25, 8, v5
    v_mfma_f32_32x32x16_bf16 v[120:135], a[44:47], a[12:15], v[120:135]
    ds_read_b128 a[60:63], v71 offset:32768
    v_max3_f32 v11, v11, v106, v107
    v_lshl_add_u32 v5, v28, 11, v5
    s_waitcnt vmcnt(24)
    s_barrier
    s_waitcnt lgkmcnt(2)
    v_mfma_f32_32x32x16_bf16 v[120:135], a[48:51], a[16:19], v[120:135]
    ds_read_b128 a[32:35], v52 offset:0
    v_max3_f32 v11, v11, v108, v109
    v_xor_b32 v6, s56, v27
    v_mfma_f32_32x32x16_bf16 v[120:135], a[52:55], a[20:23], v[120:135]
    ds_read_b128 a[36:39], v55 offset:0
    v_max3_f32 v11, v11, v110, v111
    v_lshl_add_u32 v5, v6, 5, v5
    s_waitcnt lgkmcnt(2)
    v_mfma_f32_32x32x16_bf16 v[120:135], a[56:59], a[24:27], v[120:135]
    ds_read_b128 a[40:43], v58 offset:0
    v_max3_f32 v11, v11, v112, v113
    v_max3_f32 v11, v11, v114, v115
    v_add_u32 v35, v5, v26
    v_mfma_f32_32x32x16_bf16 v[120:135], a[60:63], a[28:31], v[120:135]
    ds_read_b128 a[44:47], v61 offset:0
    v_max3_f32 v11, v11, v116, v117
    v_max3_f32 v11, v11, v118, v119
    v_add_u32 v36, 0x10000, v35
    v_add_u32 v37, 0x20000, v35
    s_waitcnt lgkmcnt(2)
    v_mfma_f32_32x32x16_bf16 v[136:151], a[32:35], a[0:3], 0
    ds_read_b128 a[48:51], v64 offset:0
    v_mov_b32 v38, v23
    v_add_u32 v39, 0x10000, v23
    v_mfma_f32_32x32x16_bf16 v[136:151], a[36:39], a[4:7], v[136:151]
    ds_read_b128 a[52:55], v67 offset:0
    v_add_u32 v40, 0x20000, v23
    s_lshl_b32 s56, s2, 7
    s_waitcnt lgkmcnt(2)
    v_mfma_f32_32x32x16_bf16 v[136:151], a[40:43], a[8:11], v[136:151]
    ds_read_b128 a[56:59], v70 offset:0
    v_max3_f32 v11, v11, v120, v121
    s_add_u32 s56, s56, 196608
    v_mfma_f32_32x32x16_bf16 v[136:151], a[44:47], a[12:15], v[136:151]
    ds_read_b128 a[60:63], v73 offset:0
    v_max3_f32 v11, v11, v122, v123
    v_mov_b32 v32, s56
    s_waitcnt vmcnt(20)
    s_barrier
    s_waitcnt lgkmcnt(2)
    v_mfma_f32_32x32x16_bf16 v[136:151], a[48:51], a[16:19], v[136:151]
    ds_read_b128 a[32:35], v50 offset:0
    v_max3_f32 v11, v11, v124, v125
    v_and_b32 v1, 3, v9
    v_mfma_f32_32x32x16_bf16 v[136:151], a[52:55], a[20:23], v[136:151]
    ds_read_b128 a[36:39], v53 offset:0
    v_max3_f32 v11, v11, v126, v127
    v_max_u32 v1, 1, v1
    s_waitcnt lgkmcnt(2)
    v_mfma_f32_32x32x16_bf16 v[136:151], a[56:59], a[24:27], v[136:151]
    ds_read_b128 a[40:43], v56 offset:0
    v_max3_f32 v11, v11, v128, v129
    v_max3_f32 v11, v11, v130, v131
    v_xor_b32 v1, s2, v1
    v_mfma_f32_32x32x16_bf16 v[136:151], a[60:63], a[28:31], v[136:151]
    ds_read_b128 a[44:47], v59 offset:0
    v_max3_f32 v11, v11, v132, v133
    v_max3_f32 v11, v11, v134, v135
    v_lshlrev_b32 v1, 7, v1
    v_add_u32 v33, 196608, v1
    s_waitcnt lgkmcnt(2)
    v_mfma_f32_32x32x16_bf16 v[152:167], a[32:35], a[0:3], 0
    ds_read_b128 a[48:51], v62 offset:0
    s_lshr_b32 s56, s36, 1
    s_lshl_b32 s56, s56, 5
    v_mfma_f32_32x32x16_bf16 v[152:167], a[36:39], a[4:7], v[152:167]
    ds_read_b128 a[52:55], v65 offset:0
    s_lshl_b32 s58, s38, 6
    s_add_u32 s56, s56, s58
    s_waitcnt lgkmcnt(2)
    v_mfma_f32_32x32x16_bf16 v[152:167], a[40:43], a[8:11], v[152:167]
    ds_read_b128 a[56:59], v68 offset:0
    v_max3_f32 v11, v11, v136, v137
    v_and_b32 v3, 31, v9
    v_mfma_f32_32x32x16_bf16 v[152:167], a[44:47], a[12:15], v[152:167]
    ds_read_b128 a[60:63], v71 offset:0
    v_max3_f32 v11, v11, v138, v139
    v_add_u32 v3, s56, v3
    s_waitcnt vmcnt(16)
    s_barrier
    s_waitcnt lgkmcnt(2)
    v_mfma_f32_32x32x16_bf16 v[152:167], a[48:51], a[16:19], v[152:167]
    s_add_u32 m0, s44, 114688
    s_add_u32 s48, s48, 8192
    s_and_b32 s48, s48, 0xffff
    buffer_load_dwordx4 v19, s[16:19], s48 offen  lds
    ds_read_b128 a[32:35], v51 offset:16384
    v_max3_f32 v11, v11, v140, v141
    v_lshlrev_b32 v3, 11, v3
    v_mfma_f32_32x32x16_bf16 v[152:167], a[52:55], a[20:23], v[152:167]
    buffer_load_dwordx4 v19, s[16:19], s48 offen offset:1024  lds
    ds_read_b128 a[36:39], v54 offset:16384
    v_max3_f32 v11, v11, v142, v143
    s_lshl_b32 s56, s53, 7
    s_waitcnt lgkmcnt(2)
    v_mfma_f32_32x32x16_bf16 v[152:167], a[56:59], a[24:27], v[152:167]
    s_add_u32 m0, s44, 122880
    s_add_u32 s51, s48, 65536
    buffer_load_dwordx4 v19, s[16:19], s51 offen  lds
    ds_read_b128 a[40:43], v57 offset:16384
    v_max3_f32 v11, v11, v144, v145
    v_max3_f32 v11, v11, v146, v147
    s_lshl_b32 s58, s39, 5
    v_mfma_f32_32x32x16_bf16 v[152:167], a[60:63], a[28:31], v[152:167]
    buffer_load_dwordx4 v19, s[16:19], s51 offen offset:1024  lds
    ds_read_b128 a[44:47], v60 offset:16384
    v_max3_f32 v11, v11, v148, v149
    v_max3_f32 v11, v11, v150, v151
    s_add_u32 s56, s56, s58
    s_and_b32 s58, s36, 1
    s_waitcnt lgkmcnt(2)
    v_mfma_f32_32x32x16_bf16 v[168:183], a[32:35], a[0:3], 0
    ds_read_b128 a[48:51], v63 offset:16384
    s_lshl_b32 s58, s58, 4
    s_add_u32 s56, s56, s58
    v_mfma_f32_32x32x16_bf16 v[168:183], a[36:39], a[4:7], v[168:183]
    ds_read_b128 a[52:55], v66 offset:16384
    s_lshl_b32 s56, s56, 1
    v_lshl_add_u32 v3, v28, 4, v3
    s_waitcnt lgkmcnt(2)
    v_mfma_f32_32x32x16_bf16 v[168:183], a[40:43], a[8:11], v[168:183]
    ds_read_b128 a[56:59], v69 offset:16384
    v_max3_f32 v11, v11, v152, v153
    v_add_u32 v34, s56, v3
    v_mfma_f32_32x32x16_bf16 v[168:183], a[44:47], a[12:15], v[168:183]
    ds_read_b128 a[60:63], v72 offset:16384
    v_max3_f32 v11, v11, v154, v155
    s_waitcnt vmcnt(16)
    s_barrier
    s_waitcnt lgkmcnt(2)
    v_mfma_f32_32x32x16_bf16 v[168:183], a[48:51], a[16:19], v[168:183]
    s_add_u32 m0, s44, 32768
    s_add_u32 s48, s48, 8192
    s_and_b32 s48, s48, 0xffff
    buffer_load_dwordx4 v19, s[16:19], s48 offen  lds
    ds_read_b128 a[32:35], v51 offset:0
    v_max3_f32 v11, v11, v156, v157
    v_mfma_f32_32x32x16_bf16 v[168:183], a[52:55], a[20:23], v[168:183]
    buffer_load_dwordx4 v19, s[16:19], s48 offen offset:1024  lds
    ds_read_b128 a[36:39], v54 offset:0
    v_max3_f32 v11, v11, v158, v159
    s_waitcnt lgkmcnt(2)
    v_mfma_f32_32x32x16_bf16 v[168:183], a[56:59], a[24:27], v[168:183]
    s_add_u32 m0, s44, 40960
    s_add_u32 s51, s48, 65536
    buffer_load_dwordx4 v19, s[16:19], s51 offen  lds
    ds_read_b128 a[40:43], v57 offset:0
    v_max3_f32 v11, v11, v160, v161
    v_max3_f32 v11, v11, v162, v163
    v_mfma_f32_32x32x16_bf16 v[168:183], a[60:63], a[28:31], v[168:183]
    buffer_load_dwordx4 v19, s[16:19], s51 offen offset:1024  lds
    ds_read_b128 a[44:47], v60 offset:0
    v_max3_f32 v11, v11, v164, v165
    v_max3_f32 v11, v11, v166, v167
    s_waitcnt lgkmcnt(2)
    v_mfma_f32_32x32x16_bf16 v[184:199], a[32:35], a[0:3], 0
    ds_read_b128 a[48:51], v63 offset:0
    v_mfma_f32_32x32x16_bf16 v[184:199], a[36:39], a[4:7], v[184:199]
    ds_read_b128 a[52:55], v66 offset:0
    s_waitcnt lgkmcnt(2)
    v_mfma_f32_32x32x16_bf16 v[184:199], a[40:43], a[8:11], v[184:199]
    ds_read_b128 a[56:59], v69 offset:0
    v_max3_f32 v11, v11, v168, v169
    v_mfma_f32_32x32x16_bf16 v[184:199], a[44:47], a[12:15], v[184:199]
    ds_read_b128 a[60:63], v72 offset:0
    v_max3_f32 v11, v11, v170, v171
    s_waitcnt vmcnt(16)
    s_barrier
    s_waitcnt lgkmcnt(2)
    v_mfma_f32_32x32x16_bf16 v[184:199], a[48:51], a[16:19], v[184:199]
    s_add_u32 m0, s44, 131072
    s_add_u32 s48, s48, 8192
    s_and_b32 s48, s48, 0xffff
    buffer_load_dwordx4 v19, s[16:19], s48 offen  lds
    ds_read_b128 a[32:35], v50 offset:16384
    v_max3_f32 v11, v11, v172, v173
    v_mfma_f32_32x32x16_bf16 v[184:199], a[52:55], a[20:23], v[184:199]
    buffer_load_dwordx4 v19, s[16:19], s48 offen offset:1024  lds
    ds_read_b128 a[36:39], v53 offset:16384
    v_max3_f32 v11, v11, v174, v175
    s_waitcnt lgkmcnt(2)
    v_mfma_f32_32x32x16_bf16 v[184:199], a[56:59], a[24:27], v[184:199]
    s_add_u32 m0, s44, 139264
    s_add_u32 s51, s48, 65536
    buffer_load_dwordx4 v19, s[16:19], s51 offen  lds
    ds_read_b128 a[40:43], v56 offset:16384
    v_max3_f32 v11, v11, v176, v177
    v_max3_f32 v11, v11, v178, v179
    v_mfma_f32_32x32x16_bf16 v[184:199], a[60:63], a[28:31], v[184:199]
    buffer_load_dwordx4 v19, s[16:19], s51 offen offset:1024  lds
    ds_read_b128 a[44:47], v59 offset:16384
    v_max3_f32 v11, v11, v180, v181
    v_max3_f32 v11, v11, v182, v183
    s_waitcnt lgkmcnt(2)
    v_mfma_f32_32x32x16_bf16 v[200:215], a[32:35], a[0:3], 0
    ds_read_b128 a[48:51], v62 offset:16384
    v_mfma_f32_32x32x16_bf16 v[200:215], a[36:39], a[4:7], v[200:215]
    ds_read_b128 a[52:55], v65 offset:16384
    s_waitcnt lgkmcnt(2)
    v_mfma_f32_32x32x16_bf16 v[200:215], a[40:43], a[8:11], v[200:215]
    ds_read_b128 a[56:59], v68 offset:16384
    v_max3_f32 v11, v11, v184, v185
    v_mfma_f32_32x32x16_bf16 v[200:215], a[44:47], a[12:15], v[200:215]
    ds_read_b128 a[60:63], v71 offset:16384
    v_max3_f32 v11, v11, v186, v187
    s_waitcnt vmcnt(16)
    s_barrier
    s_waitcnt lgkmcnt(2)
    v_mfma_f32_32x32x16_bf16 v[200:215], a[48:51], a[16:19], v[200:215]
    s_add_u32 m0, s44, 0
    s_add_u32 s48, s48, 8192
    s_and_b32 s48, s48, 0xffff
    buffer_load_dwordx4 v19, s[16:19], s48 offen  lds
    ds_read_b64_tr_b16 a[64:65], v74 offset:49152
    ds_read_b64_tr_b16 a[66:67], v74 offset:51200
    v_max3_f32 v11, v11, v188, v189
    v_mfma_f32_32x32x16_bf16 v[200:215], a[52:55], a[20:23], v[200:215]
    buffer_load_dwordx4 v19, s[16:19], s48 offen offset:1024  lds
    ds_read_b64_tr_b16 a[68:69], v77 offset:49152
    ds_read_b64_tr_b16 a[70:71], v77 offset:51200
    v_max3_f32 v11, v11, v190, v191
    s_waitcnt lgkmcnt(5)
    v_mfma_f32_32x32x16_bf16 v[200:215], a[56:59], a[24:27], v[200:215]
    s_add_u32 m0, s44, 8192
    s_add_u32 s51, s48, 65536
    buffer_load_dwordx4 v19, s[16:19], s51 offen  lds
    ds_read_b64_tr_b16 a[72:73], v80 offset:49152
    ds_read_b64_tr_b16 a[74:75], v80 offset:51200
    v_max3_f32 v11, v11, v192, v193
    v_max3_f32 v11, v11, v194, v195
    s_waitcnt lgkmcnt(6)
    v_mfma_f32_32x32x16_bf16 v[200:215], a[60:63], a[28:31], v[200:215]
    buffer_load_dwordx4 v19, s[16:19], s51 offen offset:1024  lds
    ds_read_b64_tr_b16 a[76:77], v83 offset:49152
    ds_read_b64_tr_b16 a[78:79], v83 offset:51200
    v_max3_f32 v11, v11, v196, v197
    v_max3_f32 v11, v11, v198, v199
    s_cmp_eq_u32 s42, 0
    s_mov_b32 s58, 98304
    s_cselect_b32 s56, 49152, s58
    s_lshl_b32 s58, s43, 13
    s_add_u32 s59, s56, s58
    v_add_u32 v12, s59, v23
    s_xor_b32 s58, s58, 8192
    s_add_u32 s59, s56, s58
    v_add_u32 v13, s59, v23
    v_mov_b32 v1, 0x3f803f80
    v_accvgpr_write_b32 a0, v1
    v_accvgpr_write_b32 a1, v1
    v_accvgpr_write_b32 a2, v1
    v_accvgpr_write_b32 a3, v1
    v_max3_f32 v11, v11, v200, v201
    v_max3_f32 v11, v11, v202, v203
    v_max3_f32 v11, v11, v204, v205
    v_max3_f32 v11, v11, v206, v207
    v_max3_f32 v11, v11, v208, v209
    v_max3_f32 v11, v11, v210, v211
    v_max3_f32 v11, v11, v212, v213
    v_max3_f32 v11, v11, v214, v215
    v_mov_b32 v41, v11
    s_nop 1
    v_permlane32_swap_b32 v11, v41
    v_max_f32 v11, v11, v41
    v_mul_f32 v11, s61, v11
    v_sub_f32 v42, 0, v11
    v_fma_f32 v88, v88, s61, v42
    v_fma_f32 v89, v89, s61, v42
    v_fma_f32 v90, v90, s61, v42
    v_fma_f32 v91, v91, s61, v42
    v_fma_f32 v92, v92, s61, v42
    v_fma_f32 v93, v93, s61, v42
    v_fma_f32 v94, v94, s61, v42
    v_fma_f32 v95, v95, s61, v42
    v_exp_f32 v88, v88
    v_exp_f32 v89, v89
    v_exp_f32 v90, v90
    v_exp_f32 v91, v91
    v_exp_f32 v92, v92
    v_exp_f32 v93, v93
    v_exp_f32 v94, v94
    v_exp_f32 v95, v95
    v_cvt_pk_bf16_f32 v88, v88, v89
    v_cvt_pk_bf16_f32 v89, v90, v91
    v_cvt_pk_bf16_f32 v90, v92, v93
    v_cvt_pk_bf16_f32 v91, v94, v95
    v_fma_f32 v96, v96, s61, v42
    v_fma_f32 v97, v97, s61, v42
    v_fma_f32 v98, v98, s61, v42
    v_fma_f32 v99, v99, s61, v42
    v_fma_f32 v100, v100, s61, v42
    v_fma_f32 v101, v101, s61, v42
    v_fma_f32 v102, v102, s61, v42
    v_fma_f32 v103, v103, s61, v42
    v_exp_f32 v96, v96
    v_exp_f32 v97, v97
    v_exp_f32 v98, v98
    v_exp_f32 v99, v99
    v_exp_f32 v100, v100
    v_exp_f32 v101, v101
    v_exp_f32 v102, v102
    v_exp_f32 v103, v103
    v_cvt_pk_bf16_f32 v92, v96, v97
    v_cvt_pk_bf16_f32 v93, v98, v99
    v_cvt_pk_bf16_f32 v94, v100, v101
    v_cvt_pk_bf16_f32 v95, v102, v103
    s_waitcnt lgkmcnt(4)
    v_mfma_f32_32x32x16_bf16 v[216:231], a[64:67], v[88:91], 0
    ds_read_b64_tr_b16 a[80:81], v74 offset:53248
    ds_read_b64_tr_b16 a[82:83], v74 offset:55296
    v_fma_f32 v104, v104, s61, v42
    v_fma_f32 v105, v105, s61, v42
    v_fma_f32 v106, v106, s61, v42
    v_fma_f32 v107, v107, s61, v42
    v_mfma_f32_32x32x16_bf16 v[232:247], a[68:71], v[88:91], 0
    ds_read_b64_tr_b16 a[84:85], v77 offset:53248
    ds_read_b64_tr_b16 a[86:87], v77 offset:55296
    v_fma_f32 v108, v108, s61, v42
    v_fma_f32 v109, v109, s61, v42
    v_fma_f32 v110, v110, s61, v42
    v_fma_f32 v111, v111, s61, v42
    s_waitcnt lgkmcnt(4)
    v_mfma_f32_32x32x16_bf16 a[4:19], a[72:75], v[88:91], 0
    ds_read_b64_tr_b16 a[88:89], v80 offset:53248
    ds_read_b64_tr_b16 a[90:91], v80 offset:55296
    v_exp_f32 v104, v104
    v_exp_f32 v105, v105
    v_exp_f32 v106, v106
    v_exp_f32 v107, v107
    v_mfma_f32_32x32x16_bf16 a[20:35], a[76:79], v[88:91], 0
    ds_read_b64_tr_b16 a[92:93], v83 offset:53248
    ds_read_b64_tr_b16 a[94:95], v83 offset:55296
    v_exp_f32 v108, v108
    v_exp_f32 v109, v109
    v_exp_f32 v110, v110
    v_exp_f32 v111, v111
    v_mfma_f32_32x32x16_bf16 a[36:51], a[0:3], v[88:91], 0
    v_cvt_pk_bf16_f32 v104, v104, v105
    v_cvt_pk_bf16_f32 v105, v106, v107
    v_cvt_pk_bf16_f32 v106, v108, v109
    v_cvt_pk_bf16_f32 v107, v110, v111
    s_waitcnt vmcnt(16)
    s_barrier
    s_waitcnt lgkmcnt(4)
    v_mfma_f32_32x32x16_bf16 v[216:231], a[80:83], v[92:95], v[216:231]
    s_add_u32 m0, s44, 81920
    s_add_u32 s48, s48, 8192
    s_and_b32 s48, s48, 0xffff
    buffer_load_dwordx4 v19, s[16:19], s48 offen  lds
    ds_read_b64_tr_b16 a[64:65], v75 offset:32768
    ds_read_b64_tr_b16 a[66:67], v75 offset:34816
    v_fma_f32 v112, v112, s61, v42
    v_fma_f32 v113, v113, s61, v42
    v_fma_f32 v114, v114, s61, v42
    v_fma_f32 v115, v115, s61, v42
    v_mfma_f32_32x32x16_bf16 v[232:247], a[84:87], v[92:95], v[232:247]
    buffer_load_dwordx4 v19, s[16:19], s48 offen offset:1024  lds
    ds_read_b64_tr_b16 a[68:69], v78 offset:32768
    ds_read_b64_tr_b16 a[70:71], v78 offset:34816
    v_fma_f32 v116, v116, s61, v42
    v_fma_f32 v117, v117, s61, v42
    v_fma_f32 v118, v118, s61, v42
    v_fma_f32 v119, v119, s61, v42
    s_waitcnt lgkmcnt(4)
    v_mfma_f32_32x32x16_bf16 a[4:19], a[88:91], v[92:95], a[4:19]
    s_add_u32 m0, s44, 90112
    s_add_u32 s51, s48, 65536
    buffer_load_dwordx4 v19, s[16:19], s51 offen  lds
    ds_read_b64_tr_b16 a[72:73], v81 offset:32768
    ds_read_b64_tr_b16 a[74:75], v81 offset:34816
    v_exp_f32 v112, v112
    v_exp_f32 v113, v113
    v_exp_f32 v114, v114
    v_exp_f32 v115, v115
    v_mfma_f32_32x32x16_bf16 a[20:35], a[92:95], v[92:95], a[20:35]
    buffer_load_dwordx4 v19, s[16:19], s51 offen offset:1024  lds
    ds_read_b64_tr_b16 a[76:77], v84 offset:32768
    ds_read_b64_tr_b16 a[78:79], v84 offset:34816
    v_exp_f32 v116, v116
    v_exp_f32 v117, v117
    v_exp_f32 v118, v118
    v_exp_f32 v119, v119
    v_mfma_f32_32x32x16_bf16 a[36:51], a[0:3], v[92:95], a[36:51]
    v_cvt_pk_bf16_f32 v108, v112, v113
    v_cvt_pk_bf16_f32 v109, v114, v115
    v_cvt_pk_bf16_f32 v110, v116, v117
    v_cvt_pk_bf16_f32 v111, v118, v119
    s_waitcnt lgkmcnt(4)
    v_mfma_f32_32x32x16_bf16 v[216:231], a[64:67], v[104:107], v[216:231]
    ds_read_b64_tr_b16 a[80:81], v75 offset:36864
    ds_read_b64_tr_b16 a[82:83], v75 offset:38912
    v_fma_f32 v120, v120, s61, v42
    v_fma_f32 v121, v121, s61, v42
    v_fma_f32 v122, v122, s61, v42
    v_fma_f32 v123, v123, s61, v42
    v_mfma_f32_32x32x16_bf16 v[232:247], a[68:71], v[104:107], v[232:247]
    ds_read_b64_tr_b16 a[84:85], v78 offset:36864
    ds_read_b64_tr_b16 a[86:87], v78 offset:38912
    v_fma_f32 v124, v124, s61, v42
    v_fma_f32 v125, v125, s61, v42
    v_fma_f32 v126, v126, s61, v42
    v_fma_f32 v127, v127, s61, v42
    s_waitcnt lgkmcnt(4)
    v_mfma_f32_32x32x16_bf16 a[4:19], a[72:75], v[104:107], a[4:19]
    ds_read_b64_tr_b16 a[88:89], v81 offset:36864
    ds_read_b64_tr_b16 a[90:91], v81 offset:38912
    v_exp_f32 v120, v120
    v_exp_f32 v121, v121
    v_exp_f32 v122, v122
    v_exp_f32 v123, v123
    v_mfma_f32_32x32x16_bf16 a[20:35], a[76:79], v[104:107], a[20:35]
    ds_read_b64_tr_b16 a[92:93], v84 offset:36864
    ds_read_b64_tr_b16 a[94:95], v84 offset:38912
    v_exp_f32 v124, v124
    v_exp_f32 v125, v125
    v_exp_f32 v126, v126
    v_exp_f32 v127, v127
    v_mfma_f32_32x32x16_bf16 a[36:51], a[0:3], v[104:107], a[36:51]
    v_cvt_pk_bf16_f32 v120, v120, v121
    v_cvt_pk_bf16_f32 v121, v122, v123
    v_cvt_pk_bf16_f32 v122, v124, v125
    v_cvt_pk_bf16_f32 v123, v126, v127
    s_waitcnt vmcnt(16)
    s_barrier
    s_waitcnt lgkmcnt(4)
    v_mfma_f32_32x32x16_bf16 v[216:231], a[80:83], v[108:111], v[216:231]
    s_add_u32 m0, s44, 65536
    s_add_u32 s48, s48, 8192
    s_and_b32 s48, s48, 0xffff
    buffer_load_dwordx4 v19, s[16:19], s48 offen  lds
    ds_read_b64_tr_b16 a[64:65], v75 offset:49152
    ds_read_b64_tr_b16 a[66:67], v75 offset:51200
    v_fma_f32 v128, v128, s61, v42
    v_fma_f32 v129, v129, s61, v42
    v_fma_f32 v130, v130, s61, v42
    v_fma_f32 v131, v131, s61, v42
    v_mfma_f32_32x32x16_bf16 v[232:247], a[84:87], v[108:111], v[232:247]
    buffer_load_dwordx4 v19, s[16:19], s48 offen offset:1024  lds
    ds_read_b64_tr_b16 a[68:69], v78 offset:49152
    ds_read_b64_tr_b16 a[70:71], v78 offset:51200
    v_fma_f32 v132, v132, s61, v42
    v_fma_f32 v133, v133, s61, v42
    v_fma_f32 v134, v134, s61, v42
    v_fma_f32 v135, v135, s61, v42
    s_waitcnt lgkmcnt(4)
    v_mfma_f32_32x32x16_bf16 a[4:19], a[88:91], v[108:111], a[4:19]
    s_add_u32 m0, s44, 73728
    s_add_u32 s51, s48, 65536
    buffer_load_dwordx4 v19, s[16:19], s51 offen  lds
    ds_read_b64_tr_b16 a[72:73], v81 offset:49152
    ds_read_b64_tr_b16 a[74:75], v81 offset:51200
    v_exp_f32 v128, v128
    v_exp_f32 v129, v129
    v_exp_f32 v130, v130
    v_exp_f32 v131, v131
    v_mfma_f32_32x32x16_bf16 a[20:35], a[92:95], v[108:111], a[20:35]
    buffer_load_dwordx4 v19, s[16:19], s51 offen offset:1024  lds
    ds_read_b64_tr_b16 a[76:77], v84 offset:49152
    ds_read_b64_tr_b16 a[78:79], v84 offset:51200
    v_exp_f32 v132, v132
    v_exp_f32 v133, v133
    v_exp_f32 v134, v134
    v_exp_f32 v135, v135
    v_mfma_f32_32x32x16_bf16 a[36:51], a[0:3], v[108:111], a[36:51]
    v_cvt_pk_bf16_f32 v124, v128, v129
    v_cvt_pk_bf16_f32 v125, v130, v131
    v_cvt_pk_bf16_f32 v126, v132, v133
    v_cvt_pk_bf16_f32 v127, v134, v135
    s_waitcnt lgkmcnt(4)
    v_mfma_f32_32x32x16_bf16 v[216:231], a[64:67], v[120:123], v[216:231]
    ds_read_b64_tr_b16 a[80:81], v75 offset:53248
    ds_read_b64_tr_b16 a[82:83], v75 offset:55296
    v_fma_f32 v136, v136, s61, v42
    v_fma_f32 v137, v137, s61, v42
    v_fma_f32 v138, v138, s61, v42
    v_fma_f32 v139, v139, s61, v42
    v_mfma_f32_32x32x16_bf16 v[232:247], a[68:71], v[120:123], v[232:247]
    ds_read_b64_tr_b16 a[84:85], v78 offset:53248
    ds_read_b64_tr_b16 a[86:87], v78 offset:55296
    v_fma_f32 v140, v140, s61, v42
    v_fma_f32 v141, v141, s61, v42
    v_fma_f32 v142, v142, s61, v42
    v_fma_f32 v143, v143, s61, v42
    s_waitcnt lgkmcnt(4)
    v_mfma_f32_32x32x16_bf16 a[4:19], a[72:75], v[120:123], a[4:19]
    ds_read_b64_tr_b16 a[88:89], v81 offset:53248
    ds_read_b64_tr_b16 a[90:91], v81 offset:55296
    v_exp_f32 v136, v136
    v_exp_f32 v137, v137
    v_exp_f32 v138, v138
    v_exp_f32 v139, v139
    v_mfma_f32_32x32x16_bf16 a[20:35], a[76:79], v[120:123], a[20:35]
    ds_read_b64_tr_b16 a[92:93], v84 offset:53248
    ds_read_b64_tr_b16 a[94:95], v84 offset:55296
    v_exp_f32 v140, v140
    v_exp_f32 v141, v141
    v_exp_f32 v142, v142
    v_exp_f32 v143, v143
    v_mfma_f32_32x32x16_bf16 a[36:51], a[0:3], v[120:123], a[36:51]
    v_cvt_pk_bf16_f32 v136, v136, v137
    v_cvt_pk_bf16_f32 v137, v138, v139
    v_cvt_pk_bf16_f32 v138, v140, v141
    v_cvt_pk_bf16_f32 v139, v142, v143
    s_waitcnt vmcnt(16)
    s_barrier
    s_waitcnt lgkmcnt(4)
    v_mfma_f32_32x32x16_bf16 v[216:231], a[80:83], v[124:127], v[216:231]
    s_add_u32 m0, s44, 16384
    s_add_u32 s49, s94, 0
    s_and_b32 s49, s49, 0x1fffff
    buffer_load_dwordx4 v15, s[24:27], s49 offen  lds
    ds_read_b64_tr_b16 a[64:65], v74 offset:32768
    ds_read_b64_tr_b16 a[66:67], v74 offset:34816
    v_fma_f32 v144, v144, s61, v42
    v_fma_f32 v145, v145, s61, v42
    v_fma_f32 v146, v146, s61, v42
    v_fma_f32 v147, v147, s61, v42
    v_mfma_f32_32x32x16_bf16 v[232:247], a[84:87], v[124:127], v[232:247]
    buffer_load_dwordx4 v16, s[24:27], s49 offen offset:1024  lds
    ds_read_b64_tr_b16 a[68:69], v77 offset:32768
    ds_read_b64_tr_b16 a[70:71], v77 offset:34816
    v_fma_f32 v148, v148, s61, v42
    v_fma_f32 v149, v149, s61, v42
    v_fma_f32 v150, v150, s61, v42
    v_fma_f32 v151, v151, s61, v42
    s_waitcnt lgkmcnt(4)
    v_mfma_f32_32x32x16_bf16 a[4:19], a[88:91], v[124:127], a[4:19]
    s_add_u32 m0, s44, 24576
    s_add_u32 s49, s94, 65536
    s_and_b32 s49, s49, 0x1fffff
    buffer_load_dwordx4 v15, s[24:27], s49 offen  lds
    ds_read_b64_tr_b16 a[72:73], v80 offset:32768
    ds_read_b64_tr_b16 a[74:75], v80 offset:34816
    v_exp_f32 v144, v144
    v_exp_f32 v145, v145
    v_exp_f32 v146, v146
    v_exp_f32 v147, v147
    v_mfma_f32_32x32x16_bf16 a[20:35], a[92:95], v[124:127], a[20:35]
    buffer_load_dwordx4 v16, s[24:27], s49 offen offset:1024  lds
    ds_read_b64_tr_b16 a[76:77], v83 offset:32768
    ds_read_b64_tr_b16 a[78:79], v83 offset:34816
    v_exp_f32 v148, v148
    v_exp_f32 v149, v149
    v_exp_f32 v150, v150
    v_exp_f32 v151, v151
    v_mfma_f32_32x32x16_bf16 a[36:51], a[0:3], v[124:127], a[36:51]
    v_cvt_pk_bf16_f32 v140, v144, v145
    v_cvt_pk_bf16_f32 v141, v146, v147
    v_cvt_pk_bf16_f32 v142, v148, v149
    v_cvt_pk_bf16_f32 v143, v150, v151
    s_waitcnt lgkmcnt(4)
    v_mfma_f32_32x32x16_bf16 v[216:231], a[64:67], v[136:139], v[216:231]
    ds_read_b64_tr_b16 a[80:81], v74 offset:36864
    ds_read_b64_tr_b16 a[82:83], v74 offset:38912
    v_fma_f32 v152, v152, s61, v42
    v_fma_f32 v153, v153, s61, v42
    v_fma_f32 v154, v154, s61, v42
    v_fma_f32 v155, v155, s61, v42
    v_mfma_f32_32x32x16_bf16 v[232:247], a[68:71], v[136:139], v[232:247]
    ds_read_b64_tr_b16 a[84:85], v77 offset:36864
    ds_read_b64_tr_b16 a[86:87], v77 offset:38912
    v_fma_f32 v156, v156, s61, v42
    v_fma_f32 v157, v157, s61, v42
    v_fma_f32 v158, v158, s61, v42
    v_fma_f32 v159, v159, s61, v42
    s_waitcnt lgkmcnt(4)
    v_mfma_f32_32x32x16_bf16 a[4:19], a[72:75], v[136:139], a[4:19]
    ds_read_b64_tr_b16 a[88:89], v80 offset:36864
    ds_read_b64_tr_b16 a[90:91], v80 offset:38912
    v_exp_f32 v152, v152
    v_exp_f32 v153, v153
    v_exp_f32 v154, v154
    v_exp_f32 v155, v155
    v_mfma_f32_32x32x16_bf16 a[20:35], a[76:79], v[136:139], a[20:35]
    ds_read_b64_tr_b16 a[92:93], v83 offset:36864
    ds_read_b64_tr_b16 a[94:95], v83 offset:38912
    v_exp_f32 v156, v156
    v_exp_f32 v157, v157
    v_exp_f32 v158, v158
    v_exp_f32 v159, v159
    v_mfma_f32_32x32x16_bf16 a[36:51], a[0:3], v[136:139], a[36:51]
    v_cvt_pk_bf16_f32 v152, v152, v153
    v_cvt_pk_bf16_f32 v153, v154, v155
    v_cvt_pk_bf16_f32 v154, v156, v157
    v_cvt_pk_bf16_f32 v155, v158, v159
    s_waitcnt vmcnt(16)
    s_barrier
    s_waitcnt lgkmcnt(4)
    v_mfma_f32_32x32x16_bf16 v[216:231], a[80:83], v[140:143], v[216:231]
    s_add_u32 m0, s44, 114688
    s_add_u32 s49, s94, 131072
    s_and_b32 s49, s49, 0x1fffff
    buffer_load_dwordx4 v15, s[24:27], s49 offen  lds
    ds_read_b64_tr_b16 a[64:65], v76 offset:0
    ds_read_b64_tr_b16 a[66:67], v76 offset:2048
    v_fma_f32 v160, v160, s61, v42
    v_fma_f32 v161, v161, s61, v42
    v_fma_f32 v162, v162, s61, v42
    v_fma_f32 v163, v163, s61, v42
    v_mfma_f32_32x32x16_bf16 v[232:247], a[84:87], v[140:143], v[232:247]
    buffer_load_dwordx4 v16, s[24:27], s49 offen offset:1024  lds
    ds_read_b64_tr_b16 a[68:69], v79 offset:0
    ds_read_b64_tr_b16 a[70:71], v79 offset:2048
    v_fma_f32 v164, v164, s61, v42
    v_fma_f32 v165, v165, s61, v42
    v_fma_f32 v166, v166, s61, v42
    v_fma_f32 v167, v167, s61, v42
    s_waitcnt lgkmcnt(4)
    v_mfma_f32_32x32x16_bf16 a[4:19], a[88:91], v[140:143], a[4:19]
    s_add_u32 m0, s44, 122880
    s_add_u32 s49, s94, 196608
    s_and_b32 s49, s49, 0x1fffff
    buffer_load_dwordx4 v15, s[24:27], s49 offen  lds
    ds_read_b64_tr_b16 a[72:73], v82 offset:0
    ds_read_b64_tr_b16 a[74:75], v82 offset:2048
    v_exp_f32 v160, v160
    v_exp_f32 v161, v161
    v_exp_f32 v162, v162
    v_exp_f32 v163, v163
    v_mfma_f32_32x32x16_bf16 a[20:35], a[92:95], v[140:143], a[20:35]
    buffer_load_dwordx4 v16, s[24:27], s49 offen offset:1024  lds
    ds_read_b64_tr_b16 a[76:77], v85 offset:0
    ds_read_b64_tr_b16 a[78:79], v85 offset:2048
    v_exp_f32 v164, v164
    v_exp_f32 v165, v165
    v_exp_f32 v166, v166
    v_exp_f32 v167, v167
    v_mfma_f32_32x32x16_bf16 a[36:51], a[0:3], v[140:143], a[36:51]
    v_cvt_pk_bf16_f32 v156, v160, v161
    v_cvt_pk_bf16_f32 v157, v162, v163
    v_cvt_pk_bf16_f32 v158, v164, v165
    v_cvt_pk_bf16_f32 v159, v166, v167
    s_waitcnt lgkmcnt(4)
    v_mfma_f32_32x32x16_bf16 v[216:231], a[64:67], v[152:155], v[216:231]
    ds_read_b64_tr_b16 a[80:81], v76 offset:4096
    ds_read_b64_tr_b16 a[82:83], v76 offset:6144
    v_fma_f32 v168, v168, s61, v42
    v_fma_f32 v169, v169, s61, v42
    v_fma_f32 v170, v170, s61, v42
    v_fma_f32 v171, v171, s61, v42
    v_mfma_f32_32x32x16_bf16 v[232:247], a[68:71], v[152:155], v[232:247]
    ds_read_b64_tr_b16 a[84:85], v79 offset:4096
    ds_read_b64_tr_b16 a[86:87], v79 offset:6144
    v_fma_f32 v172, v172, s61, v42
    v_fma_f32 v173, v173, s61, v42
    v_fma_f32 v174, v174, s61, v42
    v_fma_f32 v175, v175, s61, v42
    s_waitcnt lgkmcnt(4)
    v_mfma_f32_32x32x16_bf16 a[4:19], a[72:75], v[152:155], a[4:19]
    ds_read_b64_tr_b16 a[88:89], v82 offset:4096
    ds_read_b64_tr_b16 a[90:91], v82 offset:6144
    v_exp_f32 v168, v168
    v_exp_f32 v169, v169
    v_exp_f32 v170, v170
    v_exp_f32 v171, v171
    v_mfma_f32_32x32x16_bf16 a[20:35], a[76:79], v[152:155], a[20:35]
    ds_read_b64_tr_b16 a[92:93], v85 offset:4096
    ds_read_b64_tr_b16 a[94:95], v85 offset:6144
    v_exp_f32 v172, v172
    v_exp_f32 v173, v173
    v_exp_f32 v174, v174
    v_exp_f32 v175, v175
    v_mfma_f32_32x32x16_bf16 a[36:51], a[0:3], v[152:155], a[36:51]
    v_cvt_pk_bf16_f32 v168, v168, v169
    v_cvt_pk_bf16_f32 v169, v170, v171
    v_cvt_pk_bf16_f32 v170, v172, v173
    v_cvt_pk_bf16_f32 v171, v174, v175
    s_waitcnt vmcnt(16)
    s_barrier
    s_waitcnt lgkmcnt(4)
    v_mfma_f32_32x32x16_bf16 v[216:231], a[80:83], v[156:159], v[216:231]
    ds_read_b64_tr_b16 a[64:65], v74 offset:0
    ds_read_b64_tr_b16 a[66:67], v74 offset:2048
    v_fma_f32 v176, v176, s61, v42
    v_fma_f32 v177, v177, s61, v42
    v_fma_f32 v178, v178, s61, v42
    v_fma_f32 v179, v179, s61, v42
    v_mfma_f32_32x32x16_bf16 v[232:247], a[84:87], v[156:159], v[232:247]
    ds_read_b64_tr_b16 a[68:69], v77 offset:0
    ds_read_b64_tr_b16 a[70:71], v77 offset:2048
    v_fma_f32 v180, v180, s61, v42
    v_fma_f32 v181, v181, s61, v42
    v_fma_f32 v182, v182, s61, v42
    v_fma_f32 v183, v183, s61, v42
    s_waitcnt lgkmcnt(4)
    v_mfma_f32_32x32x16_bf16 a[4:19], a[88:91], v[156:159], a[4:19]
    ds_read_b64_tr_b16 a[72:73], v80 offset:0
    ds_read_b64_tr_b16 a[74:75], v80 offset:2048
    v_exp_f32 v176, v176
    v_exp_f32 v177, v177
    v_exp_f32 v178, v178
    v_exp_f32 v179, v179
    v_mfma_f32_32x32x16_bf16 a[20:35], a[92:95], v[156:159], a[20:35]
    ds_read_b64_tr_b16 a[76:77], v83 offset:0
    ds_read_b64_tr_b16 a[78:79], v83 offset:2048
    v_exp_f32 v180, v180
    v_exp_f32 v181, v181
    v_exp_f32 v182, v182
    v_exp_f32 v183, v183
    v_mfma_f32_32x32x16_bf16 a[36:51], a[0:3], v[156:159], a[36:51]
    v_cvt_pk_bf16_f32 v172, v176, v177
    v_cvt_pk_bf16_f32 v173, v178, v179
    v_cvt_pk_bf16_f32 v174, v180, v181
    v_cvt_pk_bf16_f32 v175, v182, v183
    s_waitcnt lgkmcnt(4)
    v_mfma_f32_32x32x16_bf16 v[216:231], a[64:67], v[168:171], v[216:231]
    ds_read_b64_tr_b16 a[80:81], v74 offset:4096
    ds_read_b64_tr_b16 a[82:83], v74 offset:6144
    v_fma_f32 v184, v184, s61, v42
    v_fma_f32 v185, v185, s61, v42
    v_fma_f32 v186, v186, s61, v42
    v_fma_f32 v187, v187, s61, v42
    v_mfma_f32_32x32x16_bf16 v[232:247], a[68:71], v[168:171], v[232:247]
    ds_read_b64_tr_b16 a[84:85], v77 offset:4096
    ds_read_b64_tr_b16 a[86:87], v77 offset:6144
    v_fma_f32 v188, v188, s61, v42
    v_fma_f32 v189, v189, s61, v42
    v_fma_f32 v190, v190, s61, v42
    v_fma_f32 v191, v191, s61, v42
    s_waitcnt lgkmcnt(4)
    v_mfma_f32_32x32x16_bf16 a[4:19], a[72:75], v[168:171], a[4:19]
    ds_read_b64_tr_b16 a[88:89], v80 offset:4096
    ds_read_b64_tr_b16 a[90:91], v80 offset:6144
    v_exp_f32 v184, v184
    v_exp_f32 v185, v185
    v_exp_f32 v186, v186
    v_exp_f32 v187, v187
    v_mfma_f32_32x32x16_bf16 a[20:35], a[76:79], v[168:171], a[20:35]
    ds_read_b64_tr_b16 a[92:93], v83 offset:4096
    ds_read_b64_tr_b16 a[94:95], v83 offset:6144
    v_exp_f32 v188, v188
    v_exp_f32 v189, v189
    v_exp_f32 v190, v190
    v_exp_f32 v191, v191
    v_mfma_f32_32x32x16_bf16 a[36:51], a[0:3], v[168:171], a[36:51]
    v_cvt_pk_bf16_f32 v184, v184, v185
    v_cvt_pk_bf16_f32 v185, v186, v187
    v_cvt_pk_bf16_f32 v186, v188, v189
    v_cvt_pk_bf16_f32 v187, v190, v191
    s_waitcnt vmcnt(12)
    s_barrier
    s_waitcnt lgkmcnt(4)
    v_mfma_f32_32x32x16_bf16 v[216:231], a[80:83], v[172:175], v[216:231]
    s_add_u32 m0, s44, 32768
    s_add_u32 s49, s94, 262144
    s_and_b32 s49, s49, 0x1fffff
    buffer_load_dwordx4 v15, s[24:27], s49 offen  lds
    ds_read_b64_tr_b16 a[64:65], v75 offset:16384
    ds_read_b64_tr_b16 a[66:67], v75 offset:18432
    v_fma_f32 v192, v192, s61, v42
    v_fma_f32 v193, v193, s61, v42
    v_fma_f32 v194, v194, s61, v42
    v_fma_f32 v195, v195, s61, v42
    v_mfma_f32_32x32x16_bf16 v[232:247], a[84:87], v[172:175], v[232:247]
    buffer_load_dwordx4 v16, s[24:27], s49 offen offset:1024  lds
    ds_read_b64_tr_b16 a[68:69], v78 offset:16384
    ds_read_b64_tr_b16 a[70:71], v78 offset:18432
    v_fma_f32 v196, v196, s61, v42
    v_fma_f32 v197, v197, s61, v42
    v_fma_f32 v198, v198, s61, v42
    v_fma_f32 v199, v199, s61, v42
    s_waitcnt lgkmcnt(4)
    v_mfma_f32_32x32x16_bf16 a[4:19], a[88:91], v[172:175], a[4:19]
    s_add_u32 m0, s44, 40960
    s_add_u32 s49, s94, 327680
    s_and_b32 s49, s49, 0x1fffff
    buffer_load_dwordx4 v15, s[24:27], s49 offen  lds
    ds_read_b64_tr_b16 a[72:73], v81 offset:16384
    ds_read_b64_tr_b16 a[74:75], v81 offset:18432
    v_exp_f32 v192, v192
    v_exp_f32 v193, v193
    v_exp_f32 v194, v194
    v_exp_f32 v195, v195
    v_mfma_f32_32x32x16_bf16 a[20:35], a[92:95], v[172:175], a[20:35]
    buffer_load_dwordx4 v16, s[24:27], s49 offen offset:1024  lds
    ds_read_b64_tr_b16 a[76:77], v84 offset:16384
    ds_read_b64_tr_b16 a[78:79], v84 offset:18432
    v_exp_f32 v196, v196
    v_exp_f32 v197, v197
    v_exp_f32 v198, v198
    v_exp_f32 v199, v199
    v_mfma_f32_32x32x16_bf16 a[36:51], a[0:3], v[172:175], a[36:51]
    v_cvt_pk_bf16_f32 v188, v192, v193
    v_cvt_pk_bf16_f32 v189, v194, v195
    v_cvt_pk_bf16_f32 v190, v196, v197
    v_cvt_pk_bf16_f32 v191, v198, v199
    s_waitcnt lgkmcnt(4)
    v_mfma_f32_32x32x16_bf16 v[216:231], a[64:67], v[184:187], v[216:231]
    ds_read_b64_tr_b16 a[80:81], v75 offset:20480
    ds_read_b64_tr_b16 a[82:83], v75 offset:22528
    v_fma_f32 v200, v200, s61, v42
    v_fma_f32 v201, v201, s61, v42
    v_fma_f32 v202, v202, s61, v42
    v_fma_f32 v203, v203, s61, v42
    v_mfma_f32_32x32x16_bf16 v[232:247], a[68:71], v[184:187], v[232:247]
    ds_read_b64_tr_b16 a[84:85], v78 offset:20480
    ds_read_b64_tr_b16 a[86:87], v78 offset:22528
    v_fma_f32 v204, v204, s61, v42
    v_fma_f32 v205, v205, s61, v42
    v_fma_f32 v206, v206, s61, v42
    v_fma_f32 v207, v207, s61, v42
    s_waitcnt lgkmcnt(4)
    v_mfma_f32_32x32x16_bf16 a[4:19], a[72:75], v[184:187], a[4:19]
    ds_read_b64_tr_b16 a[88:89], v81 offset:20480
    ds_read_b64_tr_b16 a[90:91], v81 offset:22528
    v_exp_f32 v200, v200
    v_exp_f32 v201, v201
    v_exp_f32 v202, v202
    v_exp_f32 v203, v203
    v_mfma_f32_32x32x16_bf16 a[20:35], a[76:79], v[184:187], a[20:35]
    ds_read_b64_tr_b16 a[92:93], v84 offset:20480
    ds_read_b64_tr_b16 a[94:95], v84 offset:22528
    v_exp_f32 v204, v204
    v_exp_f32 v205, v205
    v_exp_f32 v206, v206
    v_exp_f32 v207, v207
    v_mfma_f32_32x32x16_bf16 a[36:51], a[0:3], v[184:187], a[36:51]
    v_cvt_pk_bf16_f32 v200, v200, v201
    v_cvt_pk_bf16_f32 v201, v202, v203
    v_cvt_pk_bf16_f32 v202, v204, v205
    v_cvt_pk_bf16_f32 v203, v206, v207
    s_waitcnt vmcnt(12)
    s_barrier
    s_waitcnt lgkmcnt(4)
    v_mfma_f32_32x32x16_bf16 v[216:231], a[80:83], v[188:191], v[216:231]
    ds_read_b64_tr_b16 a[64:65], v75 offset:0
    ds_read_b64_tr_b16 a[66:67], v75 offset:2048
    v_fma_f32 v208, v208, s61, v42
    v_fma_f32 v209, v209, s61, v42
    v_fma_f32 v210, v210, s61, v42
    v_fma_f32 v211, v211, s61, v42
    v_mfma_f32_32x32x16_bf16 v[232:247], a[84:87], v[188:191], v[232:247]
    ds_read_b64_tr_b16 a[68:69], v78 offset:0
    ds_read_b64_tr_b16 a[70:71], v78 offset:2048
    v_fma_f32 v212, v212, s61, v42
    v_fma_f32 v213, v213, s61, v42
    v_fma_f32 v214, v214, s61, v42
    v_fma_f32 v215, v215, s61, v42
    s_waitcnt lgkmcnt(4)
    v_mfma_f32_32x32x16_bf16 a[4:19], a[88:91], v[188:191], a[4:19]
    ds_read_b64_tr_b16 a[72:73], v81 offset:0
    ds_read_b64_tr_b16 a[74:75], v81 offset:2048
    v_exp_f32 v208, v208
    v_exp_f32 v209, v209
    v_exp_f32 v210, v210
    v_exp_f32 v211, v211
    v_mfma_f32_32x32x16_bf16 a[20:35], a[92:95], v[188:191], a[20:35]
    ds_read_b64_tr_b16 a[76:77], v84 offset:0
    ds_read_b64_tr_b16 a[78:79], v84 offset:2048
    v_exp_f32 v212, v212
    v_exp_f32 v213, v213
    v_exp_f32 v214, v214
    v_exp_f32 v215, v215
    v_mfma_f32_32x32x16_bf16 a[36:51], a[0:3], v[188:191], a[36:51]
    v_cvt_pk_bf16_f32 v204, v208, v209
    v_cvt_pk_bf16_f32 v205, v210, v211
    v_cvt_pk_bf16_f32 v206, v212, v213
    v_cvt_pk_bf16_f32 v207, v214, v215
    s_waitcnt lgkmcnt(4)
    v_mfma_f32_32x32x16_bf16 v[216:231], a[64:67], v[200:203], v[216:231]
    ds_read_b64_tr_b16 a[80:81], v75 offset:4096
    ds_read_b64_tr_b16 a[82:83], v75 offset:6144
    v_mfma_f32_32x32x16_bf16 v[232:247], a[68:71], v[200:203], v[232:247]
    ds_read_b64_tr_b16 a[84:85], v78 offset:4096
    ds_read_b64_tr_b16 a[86:87], v78 offset:6144
    s_waitcnt lgkmcnt(4)
    v_mfma_f32_32x32x16_bf16 a[4:19], a[72:75], v[200:203], a[4:19]
    ds_read_b64_tr_b16 a[88:89], v81 offset:4096
    ds_read_b64_tr_b16 a[90:91], v81 offset:6144
    v_mfma_f32_32x32x16_bf16 a[20:35], a[76:79], v[200:203], a[20:35]
    ds_read_b64_tr_b16 a[92:93], v84 offset:4096
    ds_read_b64_tr_b16 a[94:95], v84 offset:6144
    v_mfma_f32_32x32x16_bf16 a[36:51], a[0:3], v[200:203], a[36:51]
    s_barrier
    s_waitcnt lgkmcnt(4)
    v_mfma_f32_32x32x16_bf16 v[216:231], a[80:83], v[204:207], v[216:231]
    v_mfma_f32_32x32x16_bf16 v[232:247], a[84:87], v[204:207], v[232:247]
    s_waitcnt lgkmcnt(2)
    v_mfma_f32_32x32x16_bf16 a[4:19], a[88:91], v[204:207], a[4:19]
    s_waitcnt lgkmcnt(0)
    v_mfma_f32_32x32x16_bf16 a[20:35], a[92:95], v[204:207], a[20:35]
    v_mfma_f32_32x32x16_bf16 a[36:51], a[0:3], v[204:207], a[36:51]
    s_add_u32 m0, s44, 131072
    s_add_u32 s49, s94, 393216
    s_and_b32 s49, s49, 0x1fffff
    buffer_load_dwordx4 v15, s[24:27], s49 offen  lds
    buffer_load_dwordx4 v16, s[24:27], s49 offen offset:1024  lds
    s_add_u32 m0, s44, 139264
    s_add_u32 s49, s94, 458752
    s_and_b32 s49, s49, 0x1fffff
    buffer_load_dwordx4 v15, s[24:27], s49 offen  lds
    buffer_load_dwordx4 v16, s[24:27], s49 offen offset:1024  lds
    ds_write_b32 v14, v11
    ds_write_b128 v12, a[4:7] offset:0
    ds_write_b128 v12, a[8:11] offset:1024
    ds_write_b128 v12, a[12:15] offset:2048
    ds_write_b128 v12, a[16:19] offset:3072
    ds_write_b128 v12, a[20:23] offset:4096
    ds_write_b128 v12, a[24:27] offset:5120
    ds_write_b128 v12, a[28:31] offset:6144
    ds_write_b128 v12, a[32:35] offset:7168
    ds_write_b32 v14, a36 offset:256
    v_accvgpr_read_b32 v48, a36
    s_waitcnt lgkmcnt(0)
    s_barrier
    ds_read_b32 v50, v24
    ds_read_b32 v51, v24 offset:256
    ds_read_b128 v[88:91], v13 offset:0
    ds_read_b128 v[92:95], v13 offset:1024
    ds_read_b128 v[96:99], v13 offset:2048
    ds_read_b128 v[100:103], v13 offset:3072
    ds_read_b128 v[104:107], v13 offset:4096
    ds_read_b128 v[108:111], v13 offset:5120
    ds_read_b128 v[112:115], v13 offset:6144
    ds_read_b128 v[116:119], v13 offset:7168
    s_waitcnt lgkmcnt(9)
    v_max_f32 v52, v11, v50
    v_sub_f32 v54, v11, v52
    v_sub_f32 v56, v50, v52
    v_exp_f32 v54, v54
    v_exp_f32 v56, v56
    v_mul_f32 v48, v48, v54
    s_waitcnt lgkmcnt(8)
    v_fma_f32 v48, v51, v56, v48
    v_rcp_f32 v48, v48
    s_nop 0
    v_mul_f32 v54, v54, v48
    v_mul_f32 v56, v56, v48
    v_mov_b32 v55, v54
    v_mov_b32 v57, v56
    v_pk_mul_f32 v[216:217], v[216:217], v[54:55]
    v_pk_mul_f32 v[218:219], v[218:219], v[54:55]
    v_pk_mul_f32 v[220:221], v[220:221], v[54:55]
    v_pk_mul_f32 v[222:223], v[222:223], v[54:55]
    s_waitcnt lgkmcnt(7)
    v_pk_fma_f32 v[216:217], v[88:89], v[56:57], v[216:217]
    v_pk_fma_f32 v[218:219], v[90:91], v[56:57], v[218:219]
    s_waitcnt lgkmcnt(6)
    v_pk_fma_f32 v[220:221], v[92:93], v[56:57], v[220:221]
    v_pk_fma_f32 v[222:223], v[94:95], v[56:57], v[222:223]
    v_cvt_pk_bf16_f32 v120, v216, v217
    v_cvt_pk_bf16_f32 v121, v218, v219
    v_cvt_pk_bf16_f32 v122, v220, v221
    v_cvt_pk_bf16_f32 v123, v222, v223
    v_pk_mul_f32 v[224:225], v[224:225], v[54:55]
    v_pk_mul_f32 v[226:227], v[226:227], v[54:55]
    v_pk_mul_f32 v[228:229], v[228:229], v[54:55]
    v_pk_mul_f32 v[230:231], v[230:231], v[54:55]
    s_waitcnt lgkmcnt(5)
    v_pk_fma_f32 v[224:225], v[96:97], v[56:57], v[224:225]
    v_pk_fma_f32 v[226:227], v[98:99], v[56:57], v[226:227]
    s_waitcnt lgkmcnt(4)
    v_pk_fma_f32 v[228:229], v[100:101], v[56:57], v[228:229]
    v_pk_fma_f32 v[230:231], v[102:103], v[56:57], v[230:231]
    v_cvt_pk_bf16_f32 v124, v224, v225
    v_cvt_pk_bf16_f32 v125, v226, v227
    v_cvt_pk_bf16_f32 v126, v228, v229
    v_cvt_pk_bf16_f32 v127, v230, v231
    v_pk_mul_f32 v[232:233], v[232:233], v[54:55]
    v_pk_mul_f32 v[234:235], v[234:235], v[54:55]
    v_pk_mul_f32 v[236:237], v[236:237], v[54:55]
    v_pk_mul_f32 v[238:239], v[238:239], v[54:55]
    s_waitcnt lgkmcnt(3)
    v_pk_fma_f32 v[232:233], v[104:105], v[56:57], v[232:233]
    v_pk_fma_f32 v[234:235], v[106:107], v[56:57], v[234:235]
    s_waitcnt lgkmcnt(2)
    v_pk_fma_f32 v[236:237], v[108:109], v[56:57], v[236:237]
    v_pk_fma_f32 v[238:239], v[110:111], v[56:57], v[238:239]
    v_cvt_pk_bf16_f32 v128, v232, v233
    v_cvt_pk_bf16_f32 v129, v234, v235
    v_cvt_pk_bf16_f32 v130, v236, v237
    v_cvt_pk_bf16_f32 v131, v238, v239
    v_pk_mul_f32 v[240:241], v[240:241], v[54:55]
    v_pk_mul_f32 v[242:243], v[242:243], v[54:55]
    v_pk_mul_f32 v[244:245], v[244:245], v[54:55]
    v_pk_mul_f32 v[246:247], v[246:247], v[54:55]
    s_waitcnt lgkmcnt(1)
    v_pk_fma_f32 v[240:241], v[112:113], v[56:57], v[240:241]
    v_pk_fma_f32 v[242:243], v[114:115], v[56:57], v[242:243]
    s_waitcnt lgkmcnt(0)
    v_pk_fma_f32 v[244:245], v[116:117], v[56:57], v[244:245]
    v_pk_fma_f32 v[246:247], v[118:119], v[56:57], v[246:247]
    v_cvt_pk_bf16_f32 v132, v240, v241
    v_cvt_pk_bf16_f32 v133, v242, v243
    v_cvt_pk_bf16_f32 v134, v244, v245
    v_cvt_pk_bf16_f32 v135, v246, v247
    s_cmp_eq_u32 s92, 1
    s_cbranch_scc0 L_slow_10
    buffer_store_dwordx4 v[120:123], v23, s[80:83], s62 offen offset:0
    buffer_store_dwordx4 v[124:127], v23, s[80:83], s62 offen offset:2048
    buffer_store_dwordx4 v[128:131], v23, s[80:83], s63 offen offset:0
    buffer_store_dwordx4 v[132:135], v23, s[80:83], s63 offen offset:2048
    s_branch L_stored_11
L_slow_10:
    buffer_store_dwordx4 v[120:123], v23, s[80:83], s62 offen offset:0 sc1
    buffer_store_dwordx4 v[124:127], v23, s[80:83], s62 offen offset:2048 sc1
    buffer_store_dwordx4 v[128:131], v23, s[80:83], s63 offen offset:0 sc1
    buffer_store_dwordx4 v[132:135], v23, s[80:83], s63 offen offset:2048 sc1
L_stored_11:
    s_add_u32 m0, s44, 0
    s_add_u32 s49, s94, 524288
    s_and_b32 s49, s49, 0x1fffff
    buffer_load_dwordx4 v15, s[24:27], s49 offen  lds
    buffer_load_dwordx4 v16, s[24:27], s49 offen offset:1024  lds
    s_add_u32 m0, s44, 8192
    s_add_u32 s49, s94, 589824
    s_and_b32 s49, s49, 0x1fffff
    buffer_load_dwordx4 v15, s[24:27], s49 offen  lds
    buffer_load_dwordx4 v16, s[24:27], s49 offen offset:1024  lds
    s_add_u32 m0, s44, 81920
    s_add_u32 s49, s94, 655360
    s_and_b32 s49, s49, 0x1fffff
    buffer_load_dwordx4 v15, s[24:27], s49 offen  lds
    buffer_load_dwordx4 v16, s[24:27], s49 offen offset:1024  lds
    s_add_u32 m0, s44, 90112
    s_add_u32 s49, s94, 720896
    s_and_b32 s49, s49, 0x1fffff
    buffer_load_dwordx4 v15, s[24:27], s49 offen  lds
    buffer_load_dwordx4 v16, s[24:27], s49 offen offset:1024  lds
    s_waitcnt vmcnt(8)
    s_barrier
    s_cmp_lg_u32 s39, 0
    s_cbranch_scc1 L_noflag_12
    s_mov_b64 exec, 1
    s_cmp_eq_u32 s92, 1
    s_cbranch_scc0 L_slowf_13
    buffer_store_dword v44, v29, s[32:35], 0 offen
    s_branch L_flagged_14
L_slowf_13:
    buffer_store_dword v44, v29, s[32:35], 0 offen sc1
L_flagged_14:
    s_mov_b64 exec, -1
L_noflag_12:
    s_mov_b32 s54, 200000
L_poll_15:
    buffer_load_dword v45, v30, s[32:35], 0 offen sc1
    s_waitcnt vmcnt(0)
    v_cmp_ne_u32 vcc, s52, v45
    s_nop 4
    s_cbranch_vccz L_pdone_16
    s_sub_u32 s54, s54, 1
    s_cbranch_scc0 L_poll_15
L_pdone_16:
    s_add_u32 m0, s44, 147456
    s_add_u32 s50, s50, 8192
    s_and_b32 s50, s50, 0x1ffff
    buffer_load_dwordx4 v20, s[80:83], s50 offen sc1 lds
    buffer_load_dwordx4 v21, s[80:83], s50 offen offset:1024 sc1 lds
    s_add_u32 m0, s44, 155648
    s_add_u32 s50, s50, 8192
    s_and_b32 s50, s50, 0x1ffff
    buffer_load_dwordx4 v20, s[80:83], s50 offen sc1 lds
    buffer_load_dwordx4 v21, s[80:83], s50 offen offset:1024 sc1 lds
    s_add_u32 m0, s44, 65536
    s_add_u32 s50, s50, 8192
    s_and_b32 s50, s50, 0x1ffff
    buffer_load_dwordx4 v20, s[80:83], s50 offen sc1 lds
    buffer_load_dwordx4 v21, s[80:83], s50 offen offset:1024 sc1 lds
    s_add_u32 m0, s44, 73728
    s_add_u32 s50, s50, 8192
    s_and_b32 s50, s50, 0x1ffff
    buffer_load_dwordx4 v20, s[80:83], s50 offen sc1 lds
    buffer_load_dwordx4 v21, s[80:83], s50 offen offset:1024 sc1 lds
    buffer_load_dword v53, v31, s[32:35], 0 offen sc1
    s_waitcnt vmcnt(7)
    s_barrier
    ds_read_b64_tr_b16 a[0:1], v35 offset:16384
    ds_read_b64_tr_b16 a[2:3], v35 offset:17408
    ds_read_b128 a[12:15], v40 offset:16384
    ds_read_b128 a[16:19], v40 offset:17408
    ds_read_b64_tr_b16 a[4:5], v35 offset:20480
    ds_read_b64_tr_b16 a[6:7], v35 offset:21504
    ds_read_b128 a[20:23], v40 offset:18432
    ds_read_b128 a[24:27], v40 offset:19456
    s_waitcnt lgkmcnt(4)
    v_mfma_f32_32x32x16_bf16 v[88:103], a[0:3], a[12:15], 0
    ds_read_b64_tr_b16 a[8:9], v35 offset:24576
    ds_read_b64_tr_b16 a[10:11], v35 offset:25600
    v_mfma_f32_32x32x16_bf16 v[104:119], a[0:3], a[16:19], 0
    ds_read_b128 a[28:31], v40 offset:20480
    ds_read_b128 a[32:35], v40 offset:21504
    s_waitcnt lgkmcnt(4)
    v_mfma_f32_32x32x16_bf16 v[88:103], a[4:7], a[20:23], v[88:103]
    ds_read_b64_tr_b16 a[0:1], v35 offset:28672
    ds_read_b64_tr_b16 a[2:3], v35 offset:29696
    v_mfma_f32_32x32x16_bf16 v[104:119], a[4:7], a[24:27], v[104:119]
    ds_read_b128 a[12:15], v40 offset:22528
    ds_read_b128 a[16:19], v40 offset:23552
    s_waitcnt vmcnt(5)
    s_barrier
    s_waitcnt vmcnt(0)
    v_cmp_ne_u32 vcc, s52, v53
    s_nop 4
    s_cbranch_vccz L_alldone_17
    s_mov_b32 s54, 200000
L_poll_18:
    buffer_load_dword v45, v31, s[32:35], 0 offen sc1
    s_waitcnt vmcnt(0)
    v_cmp_ne_u32 vcc, s52, v45
    s_nop 4
    s_cbranch_vccz L_pdone_19
    s_sub_u32 s54, s54, 1
    s_cbranch_scc0 L_poll_18
L_pdone_19:
L_alldone_17:
    s_waitcnt lgkmcnt(4)
    v_mfma_f32_32x32x16_bf16 v[88:103], a[8:11], a[28:31], v[88:103]
    s_add_u32 m0, s44, 49152
    s_add_u32 s50, s50, 8192
    s_and_b32 s50, s50, 0x1ffff
    buffer_load_dwordx4 v20, s[80:83], s50 offen sc1 lds
    ds_read_b64_tr_b16 a[4:5], v36 offset:49152
    ds_read_b64_tr_b16 a[6:7], v36 offset:50176
    v_mfma_f32_32x32x16_bf16 v[104:119], a[8:11], a[32:35], v[104:119]
    buffer_load_dwordx4 v21, s[80:83], s50 offen offset:1024 sc1 lds
    ds_read_b128 a[20:23], v40 offset:24576
    ds_read_b128 a[24:27], v40 offset:25600
    s_waitcnt lgkmcnt(4)
    v_mfma_f32_32x32x16_bf16 v[88:103], a[0:3], a[12:15], v[88:103]
    s_add_u32 m0, s44, 57344
    s_add_u32 s50, s50, 8192
    s_and_b32 s50, s50, 0x1ffff
    buffer_load_dwordx4 v20, s[80:83], s50 offen sc1 lds
    ds_read_b64_tr_b16 a[8:9], v36 offset:53248
    ds_read_b64_tr_b16 a[10:11], v36 offset:54272
    v_mfma_f32_32x32x16_bf16 v[104:119], a[0:3], a[16:19], v[104:119]
    buffer_load_dwordx4 v21, s[80:83], s50 offen offset:1024 sc1 lds
    ds_read_b128 a[28:31], v40 offset:26624
    ds_read_b128 a[32:35], v40 offset:27648
    s_waitcnt lgkmcnt(4)
    v_mfma_f32_32x32x16_bf16 v[88:103], a[4:7], a[20:23], v[88:103]
    s_add_u32 m0, s44, 98304
    s_add_u32 s50, s50, 8192
    s_and_b32 s50, s50, 0x1ffff
    buffer_load_dwordx4 v20, s[80:83], s50 offen sc1 lds
    ds_read_b64_tr_b16 a[0:1], v36 offset:57344
    ds_read_b64_tr_b16 a[2:3], v36 offset:58368
    v_mfma_f32_32x32x16_bf16 v[104:119], a[4:7], a[24:27], v[104:119]
    buffer_load_dwordx4 v21, s[80:83], s50 offen offset:1024 sc1 lds
    ds_read_b128 a[12:15], v40 offset:28672
    ds_read_b128 a[16:19], v40 offset:29696
    s_waitcnt lgkmcnt(4)
    v_mfma_f32_32x32x16_bf16 v[88:103], a[8:11], a[28:31], v[88:103]
    s_add_u32 m0, s44, 106496
    s_add_u32 s50, s50, 8192
    s_and_b32 s50, s50, 0x1ffff
    buffer_load_dwordx4 v20, s[80:83], s50 offen sc1 lds
    ds_read_b64_tr_b16 a[4:5], v36 offset:61440
    ds_read_b64_tr_b16 a[6:7], v36 offset:62464
    v_mfma_f32_32x32x16_bf16 v[104:119], a[8:11], a[32:35], v[104:119]
    buffer_load_dwordx4 v21, s[80:83], s50 offen offset:1024 sc1 lds
    ds_read_b128 a[20:23], v40 offset:30720
    ds_read_b128 a[24:27], v40 offset:31744
    s_barrier
    s_waitcnt lgkmcnt(4)
    v_mfma_f32_32x32x16_bf16 v[88:103], a[0:3], a[12:15], v[88:103]
    s_add_u32 m0, s44, 16384
    s_add_u32 s49, s94, 786432
    s_and_b32 s49, s49, 0x1fffff
    buffer_load_dwordx4 v15, s[24:27], s49 offen  lds
    ds_read_b64_tr_b16 a[8:9], v35 offset:32768
    ds_read_b64_tr_b16 a[10:11], v35 offset:33792
    v_mfma_f32_32x32x16_bf16 v[104:119], a[0:3], a[16:19], v[104:119]
    buffer_load_dwordx4 v16, s[24:27], s49 offen offset:1024  lds
    ds_read_b128 a[28:31], v39 offset:0
    ds_read_b128 a[32:35], v39 offset:1024
    s_waitcnt lgkmcnt(4)
    v_mfma_f32_32x32x16_bf16 v[88:103], a[4:7], a[20:23], v[88:103]
    s_add_u32 m0, s44, 24576
    s_add_u32 s49, s94, 851968
    s_and_b32 s49, s49, 0x1fffff
    buffer_load_dwordx4 v15, s[24:27], s49 offen  lds
    ds_read_b64_tr_b16 a[0:1], v35 offset:36864
    ds_read_b64_tr_b16 a[2:3], v35 offset:37888
    v_mfma_f32_32x32x16_bf16 v[104:119], a[4:7], a[24:27], v[104:119]
    buffer_load_dwordx4 v16, s[24:27], s49 offen offset:1024  lds
    ds_read_b128 a[12:15], v39 offset:2048
    ds_read_b128 a[16:19], v39 offset:3072
    s_waitcnt lgkmcnt(4)
    v_mfma_f32_32x32x16_bf16 v[88:103], a[8:11], a[28:31], v[88:103]
    ds_read_b64_tr_b16 a[4:5], v35 offset:40960
    ds_read_b64_tr_b16 a[6:7], v35 offset:41984
    v_mfma_f32_32x32x16_bf16 v[104:119], a[8:11], a[32:35], v[104:119]
    ds_read_b128 a[20:23], v39 offset:4096
    ds_read_b128 a[24:27], v39 offset:5120
    s_waitcnt lgkmcnt(4)
    v_mfma_f32_32x32x16_bf16 v[88:103], a[0:3], a[12:15], v[88:103]
    ds_read_b64_tr_b16 a[8:9], v35 offset:45056
    ds_read_b64_tr_b16 a[10:11], v35 offset:46080
    v_mfma_f32_32x32x16_bf16 v[104:119], a[0:3], a[16:19], v[104:119]
    ds_read_b128 a[28:31], v39 offset:6144
    ds_read_b128 a[32:35], v39 offset:7168
    s_barrier
    s_waitcnt lgkmcnt(4)
    v_mfma_f32_32x32x16_bf16 v[88:103], a[4:7], a[20:23], v[88:103]
    s_add_u32 m0, s44, 147456
    s_add_u32 s49, s94, 917504
    s_and_b32 s49, s49, 0x1fffff
    buffer_load_dwordx4 v15, s[24:27], s49 offen  lds
    ds_read_b64_tr_b16 a[0:1], v37 offset:0
    ds_read_b64_tr_b16 a[2:3], v37 offset:1024
    v_mfma_f32_32x32x16_bf16 v[104:119], a[4:7], a[24:27], v[104:119]
    buffer_load_dwordx4 v16, s[24:27], s49 offen offset:1024  lds
    ds_read_b128 a[12:15], v39 offset:8192
    ds_read_b128 a[16:19], v39 offset:9216
    s_waitcnt lgkmcnt(4)
    v_mfma_f32_32x32x16_bf16 v[88:103], a[8:11], a[28:31], v[88:103]
    s_add_u32 m0, s44, 155648
    s_add_u32 s49, s94, 983040
    s_and_b32 s49, s49, 0x1fffff
    buffer_load_dwordx4 v15, s[24:27], s49 offen  lds
    ds_read_b64_tr_b16 a[4:5], v37 offset:4096
    ds_read_b64_tr_b16 a[6:7], v37 offset:5120
    v_mfma_f32_32x32x16_bf16 v[104:119], a[8:11], a[32:35], v[104:119]
    buffer_load_dwordx4 v16, s[24:27], s49 offen offset:1024  lds
    ds_read_b128 a[20:23], v39 offset:10240
    ds_read_b128 a[24:27], v39 offset:11264
    s_waitcnt lgkmcnt(4)
    v_mfma_f32_32x32x16_bf16 v[88:103], a[0:3], a[12:15], v[88:103]
    s_add_u32 m0, s44, 114688
    s_add_u32 s50, s50, 8192
    s_and_b32 s50, s50, 0x1ffff
    buffer_load_dwordx4 v20, s[80:83], s50 offen sc1 lds
    ds_read_b64_tr_b16 a[8:9], v37 offset:8192
    ds_read_b64_tr_b16 a[10:11], v37 offset:9216
    v_mfma_f32_32x32x16_bf16 v[104:119], a[0:3], a[16:19], v[104:119]
    buffer_load_dwordx4 v21, s[80:83], s50 offen offset:1024 sc1 lds
    ds_read_b128 a[28:31], v39 offset:12288
    ds_read_b128 a[32:35], v39 offset:13312
    s_waitcnt lgkmcnt(4)
    v_mfma_f32_32x32x16_bf16 v[88:103], a[4:7], a[20:23], v[88:103]
    s_add_u32 m0, s44, 122880
    s_add_u32 s50, s50, 8192
    s_and_b32 s50, s50, 0x1ffff
    buffer_load_dwordx4 v20, s[80:83], s50 offen sc1 lds
    ds_read_b64_tr_b16 a[0:1], v37 offset:12288
    ds_read_b64_tr_b16 a[2:3], v37 offset:13312
    v_mfma_f32_32x32x16_bf16 v[104:119], a[4:7], a[24:27], v[104:119]
    buffer_load_dwordx4 v21, s[80:83], s50 offen offset:1024 sc1 lds
    ds_read_b128 a[12:15], v39 offset:14336
    ds_read_b128 a[16:19], v39 offset:15360
    s_waitcnt vmcnt(18)
    s_barrier
    s_waitcnt lgkmcnt(4)
    v_mfma_f32_32x32x16_bf16 v[88:103], a[8:11], a[28:31], v[88:103]
    s_add_u32 m0, s44, 32768
    s_add_u32 s49, s94, 1048576
    s_and_b32 s49, s49, 0x1fffff
    buffer_load_dwordx4 v15, s[24:27], s49 offen  lds
    ds_read_b64_tr_b16 a[4:5], v35 offset:0
    ds_read_b64_tr_b16 a[6:7], v35 offset:1024
    v_mfma_f32_32x32x16_bf16 v[104:119], a[8:11], a[32:35], v[104:119]
    buffer_load_dwordx4 v16, s[24:27], s49 offen offset:1024  lds
    ds_read_b128 a[20:23], v38 offset:49152
    ds_read_b128 a[24:27], v38 offset:50176
    s_waitcnt lgkmcnt(4)
    v_mfma_f32_32x32x16_bf16 v[88:103], a[0:3], a[12:15], v[88:103]
    s_add_u32 m0, s44, 40960
    s_add_u32 s49, s94, 1114112
    s_and_b32 s49, s49, 0x1fffff
    buffer_load_dwordx4 v15, s[24:27], s49 offen  lds
    ds_read_b64_tr_b16 a[8:9], v35 offset:4096
    ds_read_b64_tr_b16 a[10:11], v35 offset:5120
    v_mfma_f32_32x32x16_bf16 v[104:119], a[0:3], a[16:19], v[104:119]
    buffer_load_dwordx4 v16, s[24:27], s49 offen offset:1024  lds
    ds_read_b128 a[28:31], v38 offset:51200
    ds_read_b128 a[32:35], v38 offset:52224
    s_waitcnt lgkmcnt(4)
    v_mfma_f32_32x32x16_bf16 v[88:103], a[4:7], a[20:23], v[88:103]
    ds_read_b64_tr_b16 a[0:1], v35 offset:8192
    ds_read_b64_tr_b16 a[2:3], v35 offset:9216
    v_mfma_f32_32x32x16_bf16 v[104:119], a[4:7], a[24:27], v[104:119]
    ds_read_b128 a[12:15], v38 offset:53248
    ds_read_b128 a[16:19], v38 offset:54272
    s_waitcnt lgkmcnt(4)
    v_mfma_f32_32x32x16_bf16 v[88:103], a[8:11], a[28:31], v[88:103]
    ds_read_b64_tr_b16 a[4:5], v35 offset:12288
    ds_read_b64_tr_b16 a[6:7], v35 offset:13312
    v_mfma_f32_32x32x16_bf16 v[104:119], a[8:11], a[32:35], v[104:119]
    ds_read_b128 a[20:23], v38 offset:55296
    ds_read_b128 a[24:27], v38 offset:56320
    s_waitcnt vmcnt(20)
    s_barrier
    s_waitcnt lgkmcnt(4)
    v_mfma_f32_32x32x16_bf16 v[88:103], a[0:3], a[12:15], v[88:103]
    s_add_u32 m0, s44, 131072
    s_add_u32 s49, s94, 1179648
    s_and_b32 s49, s49, 0x1fffff
    buffer_load_dwordx4 v15, s[24:27], s49 offen  lds
    ds_read_b64_tr_b16 a[8:9], v36 offset:16384
    ds_read_b64_tr_b16 a[10:11], v36 offset:17408
    v_mfma_f32_32x32x16_bf16 v[104:119], a[0:3], a[16:19], v[104:119]
    buffer_load_dwordx4 v16, s[24:27], s49 offen offset:1024  lds
    ds_read_b128 a[28:31], v38 offset:57344
    ds_read_b128 a[32:35], v38 offset:58368
    s_waitcnt lgkmcnt(4)
    v_mfma_f32_32x32x16_bf16 v[88:103], a[4:7], a[20:23], v[88:103]
    s_add_u32 m0, s44, 139264
    s_add_u32 s49, s94, 1245184
    s_and_b32 s49, s49, 0x1fffff
    buffer_load_dwordx4 v15, s[24:27], s49 offen  lds
    ds_read_b64_tr_b16 a[0:1], v36 offset:20480
    ds_read_b64_tr_b16 a[2:3], v36 offset:21504
    v_mfma_f32_32x32x16_bf16 v[104:119], a[4:7], a[24:27], v[104:119]
    buffer_load_dwordx4 v16, s[24:27], s49 offen offset:1024  lds
    ds_read_b128 a[12:15], v38 offset:59392
    ds_read_b128 a[16:19], v38 offset:60416
    s_waitcnt lgkmcnt(4)
    v_mfma_f32_32x32x16_bf16 v[88:103], a[8:11], a[28:31], v[88:103]
    s_add_u32 m0, s44, 65536
    s_add_u32 s50, s50, 8192
    s_and_b32 s50, s50, 0x1ffff
    buffer_load_dwordx4 v20, s[80:83], s50 offen sc1 lds
    ds_read_b64_tr_b16 a[4:5], v36 offset:24576
    ds_read_b64_tr_b16 a[6:7], v36 offset:25600
    v_mfma_f32_32x32x16_bf16 v[104:119], a[8:11], a[32:35], v[104:119]
    buffer_load_dwordx4 v21, s[80:83], s50 offen offset:1024 sc1 lds
    ds_read_b128 a[20:23], v38 offset:61440
    ds_read_b128 a[24:27], v38 offset:62464
    s_waitcnt lgkmcnt(4)
    v_mfma_f32_32x32x16_bf16 v[88:103], a[0:3], a[12:15], v[88:103]
    s_add_u32 m0, s44, 73728
    s_add_u32 s50, s50, 8192
    s_and_b32 s50, s50, 0x1ffff
    buffer_load_dwordx4 v20, s[80:83], s50 offen sc1 lds
    ds_read_b64_tr_b16 a[8:9], v36 offset:28672
    ds_read_b64_tr_b16 a[10:11], v36 offset:29696
    v_mfma_f32_32x32x16_bf16 v[104:119], a[0:3], a[16:19], v[104:119]
    buffer_load_dwordx4 v21, s[80:83], s50 offen offset:1024 sc1 lds
    ds_read_b128 a[28:31], v38 offset:63488
    ds_read_b128 a[32:35], v38 offset:64512
    s_waitcnt vmcnt(20)
    s_barrier
    s_waitcnt lgkmcnt(4)
    v_mfma_f32_32x32x16_bf16 v[88:103], a[4:7], a[20:23], v[88:103]
    s_add_u32 m0, s44, 0
    s_add_u32 s49, s94, 1310720
    s_and_b32 s49, s49, 0x1fffff
    buffer_load_dwordx4 v15, s[24:27], s49 offen  lds
    ds_read_b64_tr_b16 a[0:1], v35 offset:16384
    ds_read_b64_tr_b16 a[2:3], v35 offset:17408
    v_mfma_f32_32x32x16_bf16 v[104:119], a[4:7], a[24:27], v[104:119]
    buffer_load_dwordx4 v16, s[24:27], s49 offen offset:1024  lds
    ds_read_b128 a[12:15], v39 offset:32768
    ds_read_b128 a[16:19], v39 offset:33792
    s_waitcnt lgkmcnt(4)
    v_mfma_f32_32x32x16_bf16 v[88:103], a[8:11], a[28:31], v[88:103]
    s_add_u32 m0, s44, 8192
    s_add_u32 s49, s94, 1376256
    s_and_b32 s49, s49, 0x1fffff
    buffer_load_dwordx4 v15, s[24:27], s49 offen  lds
    ds_read_b64_tr_b16 a[4:5], v35 offset:20480
    ds_read_b64_tr_b16 a[6:7], v35 offset:21504
    v_mfma_f32_32x32x16_bf16 v[104:119], a[8:11], a[32:35], v[104:119]
    buffer_load_dwordx4 v16, s[24:27], s49 offen offset:1024  lds
    ds_read_b128 a[20:23], v39 offset:34816
    ds_read_b128 a[24:27], v39 offset:35840
    s_waitcnt lgkmcnt(4)
    v_mfma_f32_32x32x16_bf16 v[88:103], a[0:3], a[12:15], v[88:103]
    ds_read_b64_tr_b16 a[8:9], v35 offset:24576
    ds_read_b64_tr_b16 a[10:11], v35 offset:25600
    v_mfma_f32_32x32x16_bf16 v[104:119], a[0:3], a[16:19], v[104:119]
    ds_read_b128 a[28:31], v39 offset:36864
    ds_read_b128 a[32:35], v39 offset:37888
    s_waitcnt lgkmcnt(4)
    v_mfma_f32_32x32x16_bf16 v[88:103], a[4:7], a[20:23], v[88:103]
    ds_read_b64_tr_b16 a[0:1], v35 offset:28672
    ds_read_b64_tr_b16 a[2:3], v35 offset:29696
    v_mfma_f32_32x32x16_bf16 v[104:119], a[4:7], a[24:27], v[104:119]
    ds_read_b128 a[12:15], v39 offset:38912
    ds_read_b128 a[16:19], v39 offset:39936
    s_waitcnt vmcnt(20)
    s_barrier
    s_waitcnt lgkmcnt(4)
    v_mfma_f32_32x32x16_bf16 v[88:103], a[8:11], a[28:31], v[88:103]
    s_add_u32 m0, s44, 81920
    s_add_u32 s49, s94, 1441792
    s_and_b32 s49, s49, 0x1fffff
    buffer_load_dwordx4 v15, s[24:27], s49 offen  lds
    ds_read_b64_tr_b16 a[4:5], v37 offset:16384
    ds_read_b64_tr_b16 a[6:7], v37 offset:17408
    v_mfma_f32_32x32x16_bf16 v[104:119], a[8:11], a[32:35], v[104:119]
    buffer_load_dwordx4 v16, s[24:27], s49 offen offset:1024  lds
    ds_read_b128 a[20:23], v39 offset:40960
    ds_read_b128 a[24:27], v39 offset:41984
    s_waitcnt lgkmcnt(4)
    v_mfma_f32_32x32x16_bf16 v[88:103], a[0:3], a[12:15], v[88:103]
    s_add_u32 m0, s44, 90112
    s_add_u32 s49, s94, 1507328
    s_and_b32 s49, s49, 0x1fffff
    buffer_load_dwordx4 v15, s[24:27], s49 offen  lds
    ds_read_b64_tr_b16 a[8:9], v37 offset:20480
    ds_read_b64_tr_b16 a[10:11], v37 offset:21504
    v_mfma_f32_32x32x16_bf16 v[104:119], a[0:3], a[16:19], v[104:119]
    buffer_load_dwordx4 v16, s[24:27], s49 offen offset:1024  lds
    ds_read_b128 a[28:31], v39 offset:43008
    ds_read_b128 a[32:35], v39 offset:44032
    s_waitcnt lgkmcnt(4)
    v_mfma_f32_32x32x16_bf16 v[88:103], a[4:7], a[20:23], v[88:103]
    s_add_u32 m0, s44, 49152
    s_add_u32 s50, s50, 8192
    s_and_b32 s50, s50, 0x1ffff
    buffer_load_dwordx4 v20, s[80:83], s50 offen sc1 lds
    ds_read_b64_tr_b16 a[0:1], v37 offset:24576
    ds_read_b64_tr_b16 a[2:3], v37 offset:25600
    v_mfma_f32_32x32x16_bf16 v[104:119], a[4:7], a[24:27], v[104:119]
    buffer_load_dwordx4 v21, s[80:83], s50 offen offset:1024 sc1 lds
    ds_read_b128 a[12:15], v39 offset:45056
    ds_read_b128 a[16:19], v39 offset:46080
    s_waitcnt lgkmcnt(4)
    v_mfma_f32_32x32x16_bf16 v[88:103], a[8:11], a[28:31], v[88:103]
    s_add_u32 m0, s44, 57344
    s_add_u32 s50, s50, 8192
    s_and_b32 s50, s50, 0x1ffff
    buffer_load_dwordx4 v20, s[80:83], s50 offen sc1 lds
    ds_read_b64_tr_b16 a[4:5], v37 offset:28672
    ds_read_b64_tr_b16 a[6:7], v37 offset:29696
    v_mfma_f32_32x32x16_bf16 v[104:119], a[8:11], a[32:35], v[104:119]
    buffer_load_dwordx4 v21, s[80:83], s50 offen offset:1024 sc1 lds
    ds_read_b128 a[20:23], v39 offset:47104
    ds_read_b128 a[24:27], v39 offset:48128
    s_waitcnt vmcnt(20)
    s_barrier
    s_waitcnt lgkmcnt(4)
    v_mfma_f32_32x32x16_bf16 v[88:103], a[0:3], a[12:15], v[88:103]
    s_add_u32 m0, s44, 16384
    s_add_u32 s49, s94, 1572864
    s_and_b32 s49, s49, 0x1fffff
    buffer_load_dwordx4 v15, s[24:27], s49 offen  lds
    ds_read_b64_tr_b16 a[8:9], v35 offset:32768
    ds_read_b64_tr_b16 a[10:11], v35 offset:33792
    v_mfma_f32_32x32x16_bf16 v[104:119], a[0:3], a[16:19], v[104:119]
    buffer_load_dwordx4 v16, s[24:27], s49 offen offset:1024  lds
    ds_read_b128 a[28:31], v39 offset:49152
    ds_read_b128 a[32:35], v39 offset:50176
    s_waitcnt lgkmcnt(4)
    v_mfma_f32_32x32x16_bf16 v[88:103], a[4:7], a[20:23], v[88:103]
    s_add_u32 m0, s44, 24576
    s_add_u32 s49, s94, 1638400
    s_and_b32 s49, s49, 0x1fffff
    buffer_load_dwordx4 v15, s[24:27], s49 offen  lds
    ds_read_b64_tr_b16 a[0:1], v35 offset:36864
    ds_read_b64_tr_b16 a[2:3], v35 offset:37888
    v_mfma_f32_32x32x16_bf16 v[104:119], a[4:7], a[24:27], v[104:119]
    buffer_load_dwordx4 v16, s[24:27], s49 offen offset:1024  lds
    ds_read_b128 a[12:15], v39 offset:51200
    ds_read_b128 a[16:19], v39 offset:52224
    s_waitcnt lgkmcnt(4)
    v_mfma_f32_32x32x16_bf16 v[88:103], a[8:11], a[28:31], v[88:103]
    ds_read_b64_tr_b16 a[4:5], v35 offset:40960
    ds_read_b64_tr_b16 a[6:7], v35 offset:41984
    v_mfma_f32_32x32x16_bf16 v[104:119], a[8:11], a[32:35], v[104:119]
    ds_read_b128 a[20:23], v39 offset:53248
    ds_read_b128 a[24:27], v39 offset:54272
    s_waitcnt lgkmcnt(4)
    v_mfma_f32_32x32x16_bf16 v[88:103], a[0:3], a[12:15], v[88:103]
    ds_read_b64_tr_b16 a[8:9], v35 offset:45056
    ds_read_b64_tr_b16 a[10:11], v35 offset:46080
    v_mfma_f32_32x32x16_bf16 v[104:119], a[0:3], a[16:19], v[104:119]
    ds_read_b128 a[28:31], v39 offset:55296
    ds_read_b128 a[32:35], v39 offset:56320
    s_waitcnt vmcnt(20)
    s_barrier
    s_waitcnt lgkmcnt(4)
    v_mfma_f32_32x32x16_bf16 v[88:103], a[4:7], a[20:23], v[88:103]
    s_add_u32 m0, s44, 147456
    s_add_u32 s49, s94, 1703936
    s_and_b32 s49, s49, 0x1fffff
    buffer_load_dwordx4 v15, s[24:27], s49 offen  lds
    ds_read_b64_tr_b16 a[0:1], v37 offset:0
    ds_read_b64_tr_b16 a[2:3], v37 offset:1024
    v_mfma_f32_32x32x16_bf16 v[104:119], a[4:7], a[24:27], v[104:119]
    buffer_load_dwordx4 v16, s[24:27], s49 offen offset:1024  lds
    ds_read_b128 a[12:15], v39 offset:57344
    ds_read_b128 a[16:19], v39 offset:58368
    s_waitcnt lgkmcnt(4)
    v_mfma_f32_32x32x16_bf16 v[88:103], a[8:11], a[28:31], v[88:103]
    s_add_u32 m0, s44, 155648
    s_add_u32 s49, s94, 1769472
    s_and_b32 s49, s49, 0x1fffff
    buffer_load_dwordx4 v15, s[24:27], s49 offen  lds
    ds_read_b64_tr_b16 a[4:5], v37 offset:4096
    ds_read_b64_tr_b16 a[6:7], v37 offset:5120
    v_mfma_f32_32x32x16_bf16 v[104:119], a[8:11], a[32:35], v[104:119]
    buffer_load_dwordx4 v16, s[24:27], s49 offen offset:1024  lds
    ds_read_b128 a[20:23], v39 offset:59392
    ds_read_b128 a[24:27], v39 offset:60416
    s_waitcnt lgkmcnt(4)
    v_mfma_f32_32x32x16_bf16 v[88:103], a[0:3], a[12:15], v[88:103]
    s_add_u32 m0, s44, 98304
    s_add_u32 s50, s50, 8192
    s_and_b32 s50, s50, 0x1ffff
    buffer_load_dwordx4 v20, s[80:83], s50 offen sc1 lds
    ds_read_b64_tr_b16 a[8:9], v37 offset:8192
    ds_read_b64_tr_b16 a[10:11], v37 offset:9216
    v_mfma_f32_32x32x16_bf16 v[104:119], a[0:3], a[16:19], v[104:119]
    buffer_load_dwordx4 v21, s[80:83], s50 offen offset:1024 sc1 lds
    ds_read_b128 a[28:31], v39 offset:61440
    ds_read_b128 a[32:35], v39 offset:62464
    s_waitcnt lgkmcnt(4)
    v_mfma_f32_32x32x16_bf16 v[88:103], a[4:7], a[20:23], v[88:103]
    s_add_u32 m0, s44, 106496
    s_add_u32 s50, s50, 8192
    s_and_b32 s50, s50, 0x1ffff
    buffer_load_dwordx4 v20, s[80:83], s50 offen sc1 lds
    ds_read_b64_tr_b16 a[0:1], v37 offset:12288
    ds_read_b64_tr_b16 a[2:3], v37 offset:13312
    v_mfma_f32_32x32x16_bf16 v[104:119], a[4:7], a[24:27], v[104:119]
    buffer_load_dwordx4 v21, s[80:83], s50 offen offset:1024 sc1 lds
    ds_read_b128 a[12:15], v39 offset:63488
    ds_read_b128 a[16:19], v39 offset:64512
    s_waitcnt vmcnt(20)
    s_barrier
    s_waitcnt lgkmcnt(4)
    v_mfma_f32_32x32x16_bf16 v[88:103], a[8:11], a[28:31], v[88:103]
    s_add_u32 m0, s44, 32768
    s_add_u32 s49, s94, 1835008
    s_and_b32 s49, s49, 0x1fffff
    buffer_load_dwordx4 v15, s[24:27], s49 offen  lds
    ds_read_b64_tr_b16 a[4:5], v35 offset:0
    ds_read_b64_tr_b16 a[6:7], v35 offset:1024
    v_mfma_f32_32x32x16_bf16 v[104:119], a[8:11], a[32:35], v[104:119]
    buffer_load_dwordx4 v16, s[24:27], s49 offen offset:1024  lds
    ds_read_b128 a[20:23], v39 offset:0
    ds_read_b128 a[24:27], v39 offset:1024
    s_waitcnt lgkmcnt(4)
    v_mfma_f32_32x32x16_bf16 v[88:103], a[0:3], a[12:15], v[88:103]
    s_add_u32 m0, s44, 40960
    s_add_u32 s49, s94, 1900544
    s_and_b32 s49, s49, 0x1fffff
    buffer_load_dwordx4 v15, s[24:27], s49 offen  lds
    ds_read_b64_tr_b16 a[8:9], v35 offset:4096
    ds_read_b64_tr_b16 a[10:11], v35 offset:5120
    v_mfma_f32_32x32x16_bf16 v[104:119], a[0:3], a[16:19], v[104:119]
    buffer_load_dwordx4 v16, s[24:27], s49 offen offset:1024  lds
    ds_read_b128 a[28:31], v39 offset:2048
    ds_read_b128 a[32:35], v39 offset:3072
    s_waitcnt lgkmcnt(4)
    v_mfma_f32_32x32x16_bf16 v[88:103], a[4:7], a[20:23], v[88:103]
    ds_read_b64_tr_b16 a[0:1], v35 offset:8192
    ds_read_b64_tr_b16 a[2:3], v35 offset:9216
    v_mfma_f32_32x32x16_bf16 v[104:119], a[4:7], a[24:27], v[104:119]
    ds_read_b128 a[12:15], v39 offset:4096
    ds_read_b128 a[16:19], v39 offset:5120
    s_waitcnt lgkmcnt(4)
    v_mfma_f32_32x32x16_bf16 v[88:103], a[8:11], a[28:31], v[88:103]
    ds_read_b64_tr_b16 a[4:5], v35 offset:12288
    ds_read_b64_tr_b16 a[6:7], v35 offset:13312
    v_mfma_f32_32x32x16_bf16 v[104:119], a[8:11], a[32:35], v[104:119]
    ds_read_b128 a[20:23], v39 offset:6144
    ds_read_b128 a[24:27], v39 offset:7168
    s_waitcnt vmcnt(20)
    s_barrier
    s_waitcnt lgkmcnt(4)
    v_mfma_f32_32x32x16_bf16 v[88:103], a[0:3], a[12:15], v[88:103]
    s_add_u32 m0, s44, 131072
    s_add_u32 s49, s94, 1966080
    s_and_b32 s49, s49, 0x1fffff
    buffer_load_dwordx4 v15, s[24:27], s49 offen  lds
    ds_read_b64_tr_b16 a[8:9], v36 offset:16384
    ds_read_b64_tr_b16 a[10:11], v36 offset:17408
    v_mfma_f32_32x32x16_bf16 v[104:119], a[0:3], a[16:19], v[104:119]
    buffer_load_dwordx4 v16, s[24:27], s49 offen offset:1024  lds
    ds_read_b128 a[28:31], v39 offset:8192
    ds_read_b128 a[32:35], v39 offset:9216
    s_waitcnt lgkmcnt(4)
    v_mfma_f32_32x32x16_bf16 v[88:103], a[4:7], a[20:23], v[88:103]
    s_add_u32 m0, s44, 139264
    s_add_u32 s49, s94, 2031616
    s_and_b32 s49, s49, 0x1fffff
    buffer_load_dwordx4 v15, s[24:27], s49 offen  lds
    ds_read_b64_tr_b16 a[0:1], v36 offset:20480
    ds_read_b64_tr_b16 a[2:3], v36 offset:21504
    v_mfma_f32_32x32x16_bf16 v[104:119], a[4:7], a[24:27], v[104:119]
    buffer_load_dwordx4 v16, s[24:27], s49 offen offset:1024  lds
    ds_read_b128 a[12:15], v39 offset:10240
    ds_read_b128 a[16:19], v39 offset:11264
    s_waitcnt lgkmcnt(4)
    v_mfma_f32_32x32x16_bf16 v[88:103], a[8:11], a[28:31], v[88:103]
    ds_read_b64_tr_b16 a[4:5], v36 offset:24576
    ds_read_b64_tr_b16 a[6:7], v36 offset:25600
    v_mfma_f32_32x32x16_bf16 v[104:119], a[8:11], a[32:35], v[104:119]
    ds_read_b128 a[20:23], v39 offset:12288
    ds_read_b128 a[24:27], v39 offset:13312
    s_waitcnt lgkmcnt(4)
    v_mfma_f32_32x32x16_bf16 v[88:103], a[0:3], a[12:15], v[88:103]
    ds_read_b64_tr_b16 a[8:9], v36 offset:28672
    ds_read_b64_tr_b16 a[10:11], v36 offset:29696
    v_mfma_f32_32x32x16_bf16 v[104:119], a[0:3], a[16:19], v[104:119]
    ds_read_b128 a[28:31], v39 offset:14336
    ds_read_b128 a[32:35], v39 offset:15360
    s_waitcnt vmcnt(16)
    s_barrier
    s_waitcnt lgkmcnt(4)
    v_mfma_f32_32x32x16_bf16 v[88:103], a[4:7], a[20:23], v[88:103]
    ds_read_b64_tr_b16 a[0:1], v35 offset:16384
    ds_read_b64_tr_b16 a[2:3], v35 offset:17408
    v_mfma_f32_32x32x16_bf16 v[104:119], a[4:7], a[24:27], v[104:119]
    ds_read_b128 a[12:15], v38 offset:49152
    ds_read_b128 a[16:19], v38 offset:50176
    s_waitcnt lgkmcnt(4)
    v_mfma_f32_32x32x16_bf16 v[88:103], a[8:11], a[28:31], v[88:103]
    ds_read_b64_tr_b16 a[4:5], v35 offset:20480
    ds_read_b64_tr_b16 a[6:7], v35 offset:21504
    v_mfma_f32_32x32x16_bf16 v[104:119], a[8:11], a[32:35], v[104:119]
    ds_read_b128 a[20:23], v38 offset:51200
    ds_read_b128 a[24:27], v38 offset:52224
    s_waitcnt lgkmcnt(4)
    v_mfma_f32_32x32x16_bf16 v[88:103], a[0:3], a[12:15], v[88:103]
    ds_read_b64_tr_b16 a[8:9], v35 offset:24576
    ds_read_b64_tr_b16 a[10:11], v35 offset:25600
    v_mfma_f32_32x32x16_bf16 v[104:119], a[0:3], a[16:19], v[104:119]
    ds_read_b128 a[28:31], v38 offset:53248
    ds_read_b128 a[32:35], v38 offset:54272
    s_waitcnt lgkmcnt(4)
    v_mfma_f32_32x32x16_bf16 v[88:103], a[4:7], a[20:23], v[88:103]
    ds_read_b64_tr_b16 a[0:1], v35 offset:28672
    ds_read_b64_tr_b16 a[2:3], v35 offset:29696
    v_mfma_f32_32x32x16_bf16 v[104:119], a[4:7], a[24:27], v[104:119]
    ds_read_b128 a[12:15], v38 offset:55296
    ds_read_b128 a[16:19], v38 offset:56320
    s_waitcnt vmcnt(12)
    s_barrier
    s_waitcnt lgkmcnt(4)
    v_mfma_f32_32x32x16_bf16 v[88:103], a[8:11], a[28:31], v[88:103]
    ds_read_b64_tr_b16 a[4:5], v37 offset:16384
    ds_read_b64_tr_b16 a[6:7], v37 offset:17408
    v_mfma_f32_32x32x16_bf16 v[104:119], a[8:11], a[32:35], v[104:119]
    ds_read_b128 a[20:23], v38 offset:57344
    ds_read_b128 a[24:27], v38 offset:58368
    s_waitcnt lgkmcnt(4)
    v_mfma_f32_32x32x16_bf16 v[88:103], a[0:3], a[12:15], v[88:103]
    ds_read_b64_tr_b16 a[8:9], v37 offset:20480
    ds_read_b64_tr_b16 a[10:11], v37 offset:21504
    v_mfma_f32_32x32x16_bf16 v[104:119], a[0:3], a[16:19], v[104:119]
    ds_read_b128 a[28:31], v38 offset:59392
    ds_read_b128 a[32:35], v38 offset:60416
    s_waitcnt lgkmcnt(4)
    v_mfma_f32_32x32x16_bf16 v[88:103], a[4:7], a[20:23], v[88:103]
    ds_read_b64_tr_b16 a[0:1], v37 offset:24576
    ds_read_b64_tr_b16 a[2:3], v37 offset:25600
    v_mfma_f32_32x32x16_bf16 v[104:119], a[4:7], a[24:27], v[104:119]
    ds_read_b128 a[12:15], v38 offset:61440
    ds_read_b128 a[16:19], v38 offset:62464
    s_waitcnt lgkmcnt(4)
    v_mfma_f32_32x32x16_bf16 v[88:103], a[8:11], a[28:31], v[88:103]
    ds_read_b64_tr_b16 a[4:5], v37 offset:28672
    ds_read_b64_tr_b16 a[6:7], v37 offset:29696
    v_mfma_f32_32x32x16_bf16 v[104:119], a[8:11], a[32:35], v[104:119]
    ds_read_b128 a[20:23], v38 offset:63488
    ds_read_b128 a[24:27], v38 offset:64512
    s_waitcnt vmcnt(4)
    s_barrier
    s_waitcnt lgkmcnt(4)
    v_mfma_f32_32x32x16_bf16 v[88:103], a[0:3], a[12:15], v[88:103]
    ds_read_b64_tr_b16 a[8:9], v35 offset:32768
    ds_read_b64_tr_b16 a[10:11], v35 offset:33792
    v_mfma_f32_32x32x16_bf16 v[104:119], a[0:3], a[16:19], v[104:119]
    ds_read_b128 a[28:31], v39 offset:32768
    ds_read_b128 a[32:35], v39 offset:33792
    s_waitcnt lgkmcnt(4)
    v_mfma_f32_32x32x16_bf16 v[88:103], a[4:7], a[20:23], v[88:103]
    ds_read_b64_tr_b16 a[0:1], v35 offset:36864
    ds_read_b64_tr_b16 a[2:3], v35 offset:37888
    v_mfma_f32_32x32x16_bf16 v[104:119], a[4:7], a[24:27], v[104:119]
    ds_read_b128 a[12:15], v39 offset:34816
    ds_read_b128 a[16:19], v39 offset:35840
    s_waitcnt lgkmcnt(4)
    v_mfma_f32_32x32x16_bf16 v[88:103], a[8:11], a[28:31], v[88:103]
    ds_read_b64_tr_b16 a[4:5], v35 offset:40960
    ds_read_b64_tr_b16 a[6:7], v35 offset:41984
    v_mfma_f32_32x32x16_bf16 v[104:119], a[8:11], a[32:35], v[104:119]
    ds_read_b128 a[20:23], v39 offset:36864
    ds_read_b128 a[24:27], v39 offset:37888
    s_waitcnt lgkmcnt(4)
    v_mfma_f32_32x32x16_bf16 v[88:103], a[0:3], a[12:15], v[88:103]
    ds_read_b64_tr_b16 a[8:9], v35 offset:45056
    ds_read_b64_tr_b16 a[10:11], v35 offset:46080
    v_mfma_f32_32x32x16_bf16 v[104:119], a[0:3], a[16:19], v[104:119]
    ds_read_b128 a[28:31], v39 offset:38912
    ds_read_b128 a[32:35], v39 offset:39936
    s_waitcnt vmcnt(0)
    s_barrier
    s_waitcnt lgkmcnt(4)
    v_mfma_f32_32x32x16_bf16 v[88:103], a[4:7], a[20:23], v[88:103]
    ds_read_b64_tr_b16 a[0:1], v37 offset:0
    ds_read_b64_tr_b16 a[2:3], v37 offset:1024
    v_mfma_f32_32x32x16_bf16 v[104:119], a[4:7], a[24:27], v[104:119]
    ds_read_b128 a[12:15], v39 offset:40960
    ds_read_b128 a[16:19], v39 offset:41984
    s_waitcnt lgkmcnt(4)
    v_mfma_f32_32x32x16_bf16 v[88:103], a[8:11], a[28:31], v[88:103]
    ds_read_b64_tr_b16 a[4:5], v37 offset:4096
    ds_read_b64_tr_b16 a[6:7], v37 offset:5120
    v_mfma_f32_32x32x16_bf16 v[104:119], a[8:11], a[32:35], v[104:119]
    ds_read_b128 a[20:23], v39 offset:43008
    ds_read_b128 a[24:27], v39 offset:44032
    s_waitcnt lgkmcnt(4)
    v_mfma_f32_32x32x16_bf16 v[88:103], a[0:3], a[12:15], v[88:103]
    ds_read_b64_tr_b16 a[8:9], v37 offset:8192
    ds_read_b64_tr_b16 a[10:11], v37 offset:9216
    v_mfma_f32_32x32x16_bf16 v[104:119], a[0:3], a[16:19], v[104:119]
    ds_read_b128 a[28:31], v39 offset:45056
    ds_read_b128 a[32:35], v39 offset:46080
    s_waitcnt lgkmcnt(4)
    v_mfma_f32_32x32x16_bf16 v[88:103], a[4:7], a[20:23], v[88:103]
    ds_read_b64_tr_b16 a[0:1], v37 offset:12288
    ds_read_b64_tr_b16 a[2:3], v37 offset:13312
    v_mfma_f32_32x32x16_bf16 v[104:119], a[4:7], a[24:27], v[104:119]
    ds_read_b128 a[12:15], v39 offset:47104
    ds_read_b128 a[16:19], v39 offset:48128
    s_barrier
    s_waitcnt lgkmcnt(4)
    v_mfma_f32_32x32x16_bf16 v[88:103], a[8:11], a[28:31], v[88:103]
    v_mfma_f32_32x32x16_bf16 v[104:119], a[8:11], a[32:35], v[104:119]
    s_waitcnt lgkmcnt(0)
    v_mfma_f32_32x32x16_bf16 v[88:103], a[0:3], a[12:15], v[88:103]
    v_mfma_f32_32x32x16_bf16 v[104:119], a[0:3], a[16:19], v[104:119]
    s_nop 10
    v_cvt_pk_bf16_f32 v124, v96, v97
    v_cvt_pk_bf16_f32 v125, v98, v99
    v_cvt_pk_bf16_f32 v126, v100, v101
    v_cvt_pk_bf16_f32 v127, v102, v103
    s_xor_b32 s56, s2, 1
    s_lshl_b32 s56, s56, 15
    s_add_u32 s56, s56, 8388608
    buffer_store_dwordx4 v[124:127], v22, s[32:35], s56 offen sc1
    v_cvt_pk_bf16_f32 v128, v104, v105
    v_cvt_pk_bf16_f32 v129, v106, v107
    v_cvt_pk_bf16_f32 v130, v108, v109
    v_cvt_pk_bf16_f32 v131, v110, v111
    s_xor_b32 s56, s2, 2
    s_lshl_b32 s56, s56, 15
    s_add_u32 s56, s56, 8396800
    buffer_store_dwordx4 v[128:131], v22, s[32:35], s56 offen sc1
    v_cvt_pk_bf16_f32 v132, v112, v113
    v_cvt_pk_bf16_f32 v133, v114, v115
    v_cvt_pk_bf16_f32 v134, v116, v117
    v_cvt_pk_bf16_f32 v135, v118, v119
    s_xor_b32 s56, s2, 3
    s_lshl_b32 s56, s56, 15
    s_add_u32 s56, s56, 8404992
    buffer_store_dwordx4 v[132:135], v22, s[32:35], s56 offen sc1
    s_waitcnt vmcnt(0)
    s_barrier
    s_cmp_lg_u32 s39, 0
    s_cbranch_scc1 L_noflag_20
    s_mov_b64 exec, 1
    buffer_store_dword v44, v32, s[32:35], 0 offen sc1
    s_mov_b64 exec, -1
L_noflag_20:
    s_mov_b32 s54, 200000
L_poll_21:
    buffer_load_dword v45, v33, s[32:35], 0 offen sc1
    s_waitcnt vmcnt(0)
    v_cmp_ne_u32 vcc, s52, v45
    s_nop 4
    s_cbranch_vccz L_pdone_22
    s_sub_u32 s54, s54, 1
    s_cbranch_scc0 L_poll_21
L_pdone_22:
    s_lshl_b32 s56, s2, 15
    s_add_u32 s56, s56, 8388608
    buffer_load_dwordx4 v[152:155], v22, s[32:35], s56 offen sc1
    s_lshl_b32 s56, s2, 15
    s_add_u32 s56, s56, 8396800
    buffer_load_dwordx4 v[156:159], v22, s[32:35], s56 offen sc1
    s_lshl_b32 s56, s2, 15
    s_add_u32 s56, s56, 8404992
    buffer_load_dwordx4 v[160:163], v22, s[32:35], s56 offen sc1
    s_waitcnt vmcnt(2)
    v_lshlrev_b32 v168, 16, v152
    v_and_b32 v169, 0xffff0000, v152
    v_add_f32 v88, v88, v168
    v_add_f32 v89, v89, v169
    v_lshlrev_b32 v168, 16, v153
    v_and_b32 v169, 0xffff0000, v153
    v_add_f32 v90, v90, v168
    v_add_f32 v91, v91, v169
    v_lshlrev_b32 v168, 16, v154
    v_and_b32 v169, 0xffff0000, v154
    v_add_f32 v92, v92, v168
    v_add_f32 v93, v93, v169
    v_lshlrev_b32 v168, 16, v155
    v_and_b32 v169, 0xffff0000, v155
    v_add_f32 v94, v94, v168
    v_add_f32 v95, v95, v169
    s_waitcnt vmcnt(1)
    v_lshlrev_b32 v168, 16, v156
    v_and_b32 v169, 0xffff0000, v156
    v_add_f32 v88, v88, v168
    v_add_f32 v89, v89, v169
    v_lshlrev_b32 v168, 16, v157
    v_and_b32 v169, 0xffff0000, v157
    v_add_f32 v90, v90, v168
    v_add_f32 v91, v91, v169
    v_lshlrev_b32 v168, 16, v158
    v_and_b32 v169, 0xffff0000, v158
    v_add_f32 v92, v92, v168
    v_add_f32 v93, v93, v169
    v_lshlrev_b32 v168, 16, v159
    v_and_b32 v169, 0xffff0000, v159
    v_add_f32 v94, v94, v168
    v_add_f32 v95, v95, v169
    s_waitcnt vmcnt(0)
    v_lshlrev_b32 v168, 16, v160
    v_and_b32 v169, 0xffff0000, v160
    v_add_f32 v88, v88, v168
    v_add_f32 v89, v89, v169
    v_lshlrev_b32 v168, 16, v161
    v_and_b32 v169, 0xffff0000, v161
    v_add_f32 v90, v90, v168
    v_add_f32 v91, v91, v169
    v_lshlrev_b32 v168, 16, v162
    v_and_b32 v169, 0xffff0000, v162
    v_add_f32 v92, v92, v168
    v_add_f32 v93, v93, v169
    v_lshlrev_b32 v168, 16, v163
    v_and_b32 v169, 0xffff0000, v163
    v_add_f32 v94, v94, v168
    v_add_f32 v95, v95, v169
    v_cvt_pk_bf16_f32 v120, v88, v89
    v_cvt_pk_bf16_f32 v121, v90, v91
    v_cvt_pk_bf16_f32 v122, v92, v93
    v_cvt_pk_bf16_f32 v123, v94, v95
    buffer_store_dwordx4 v[120:123], v34, s[28:31], 0 offen sc1
    s_and_b32 s56, s2, 0x3b
    s_or_b32 s56, s56, s39
    s_cmp_lg_u32 s56, 0
    s_cbranch_scc1 L_fin
    s_lshl_b32 s56, s38, 8
    v_mov_b32 v1, s56
    s_mov_b64 exec, 1
    buffer_store_dword v44, v1, s[32:35], 0 offen sc1
    s_mov_b64 exec, -1
L_fin:
    s_waitcnt vmcnt(0)
L_exit:
    s_endpgm
.section .rodata,"a"
.p2align 6
.amdhsa_kernel standalone__gqa_block_cached__near_ridge_kernel
  .amdhsa_next_free_vgpr 512
  .amdhsa_next_free_sgpr 96
  .amdhsa_accum_offset 256
  .amdhsa_group_segment_fixed_size 0
  .amdhsa_kernarg_size 64
  .amdhsa_user_sgpr_count 2
  .amdhsa_user_sgpr_kernarg_segment_ptr 1
  .amdhsa_system_sgpr_workgroup_id_x 1
.end_amdhsa_kernel
```
